```python
import torch

def _softmax(x, axis=-1):
    return torch.softmax(x, dim=axis)

def _gelu(x):
    return torch.nn.functional.gelu(x, approximate='tanh')

def _silu(x):
    return torch.nn.functional.silu(x)

def _sigmoid(x):
    return torch.sigmoid(x)

def _layernorm(x, axis=-1, eps=1e-05):
    m = x.mean(dim=axis, keepdim=True)
    v = x.var(dim=axis, keepdim=True, unbiased=False)
    return (x - m) / torch.sqrt(v + eps)

def _scatter_add(tgt, idx, src, axis=0):
    return tgt.clone().index_add_(axis, idx, src)

def _segment_sum(src, seg, n):
    out = torch.zeros((n,) + src.shape[1:], dtype=src.dtype)
    return out.index_add_(0, seg, src)

def _pad(x, pw):
    flat = tuple((v for pair in reversed(pw) for v in pair))
    return torch.nn.functional.pad(x, flat)
kernel_name = 'gather_scatter__tensor_product_equiv_mace__graph'

def setup_inputs():

    _w = lambda a: (lambda t: t.to(torch.bfloat16) if t.is_floating_point() else t)(torch.as_tensor(a))
    N, deg = (10000, 32)
    Lmax, C, De = (1, 128, 4)
    M = (Lmax + 1) ** 2
    E = N * deg
    src = (lambda lo, hi, *s: torch.randint(lo, hi, s))(0, N, E).to(torch.int64)
    dst = (lambda lo, hi, *s: torch.randint(lo, hi, s))(0, N, E).to(torch.int64)
    r = (lambda *s: torch.randn(*s, dtype=torch.bfloat16) * 0.05)(E, 3).to(float)
    r = r / (torch.linalg.norm(r, dim=-1, keepdim=True).to(float) + 1e-06)
    rx, ry, rz = (r[:, 0].clone(), r[:, 1].clone(), r[:, 2].clone())
    x2, y2, z2 = (rx * rx, ry * ry, rz * rz)
    sh_list = [torch.ones_like(rx), rx, ry, rz, rx * ry, ry * rz, 2.0 * z2 - x2 - y2, rx * rz, x2 - y2, ry * (3.0 * x2 - y2), rx * ry * rz, ry * (4.0 * z2 - x2 - y2), rz * (2.0 * z2 - 3.0 * x2 - 3.0 * y2), rx * (4.0 * z2 - x2 - y2), rz * (x2 - y2), rx * (x2 - 3.0 * y2)]
    sh16 = torch.stack(sh_list, dim=-1).to(float)
    pad = max(0, M - 16)
    sh_full = torch.cat([sh16, torch.zeros((E, pad), dtype=float)], dim=-1)[:, :M]
    cg = ((lambda *s: torch.randn(*s, dtype=torch.bfloat16) * 0.05)(M, M, M) * (1.0 / float(M))).to(float)
    return {'x': _w(((lambda *s: torch.randn(*s, dtype=torch.bfloat16) * 0.05)(N, M, C) * 0.3).to(float)), 'src': _w(src), 'dst': _w(dst), 'sh': _w(sh_full.to(float)), 'edge_attr': _w(((lambda *s: torch.randn(*s, dtype=torch.bfloat16) * 0.05)(E, De) * 0.3).to(float)), 'cg': _w(cg), 'w_r': _w(((lambda *s: torch.randn(*s, dtype=torch.bfloat16) * 0.05)(De, C) * (1.0 / float(De) ** 0.5)).to(float)), 'w_out': _w(((lambda *s: torch.randn(*s, dtype=torch.bfloat16) * 0.05)(C, C) * (1.0 / float(C) ** 0.5)).to(float))}

def reference(x, src, dst, sh, edge_attr, cg, w_r, w_out):
    N = x.shape[0]
    M = x.shape[1]
    C = x.shape[2]
    h = x[src]
    tp = torch.einsum('uvw,euc,ev->ewc', cg, h, sh)
    rw = edge_attr @ w_r
    msg = tp * rw[:, None, :]
    msg2 = msg.reshape(-1, M * C)
    agg = _segment_sum(msg2, dst, N).reshape(N, M, C)
    out = torch.einsum('nmc,cd->nmd', agg, w_out)
    return out
```

```asm
; @launch kernel=part_kernel grid=(258,1,1) block=(320,1,1) lds=27648
; @launch kernel=main_kernel grid=(256,1,1) block=(512,1,1) lds=140480
.amdgcn_target "amdgcn-amd-amdhsa--gfx950"
.text
.globl part_kernel
.p2align 8
.type part_kernel,@function
part_kernel:
    s_cmp_ge_u32 s2, 258
    s_cbranch_scc1 K1_end
    s_cmp_ge_u32 s2, 250
    s_cbranch_scc1 K1_wprep
    s_load_dwordx4 s[4:7], s[0:1], 8
    s_load_dwordx4 s[8:11], s[0:1], 24
    s_load_dwordx2 s[12:13], s[0:1], 80
    v_lshlrev_b32 v1, 4, v0
    v_lshlrev_b32 v2, 5, v0
    v_lshlrev_b32 v3, 2, v0
    v_mov_b32 v4, 0
    ds_write_b32 v3, v4 offset:0
    s_mul_i32 s14, s2, 5120
    s_mul_i32 s15, s2, 10240
    v_lshrrev_b32 v5, 6, v0
    s_waitcnt lgkmcnt(0)
    s_mov_b32 s20, s6
    s_and_b32 s21, s7, 0xffff
    s_mov_b32 s22, 1280000
    s_mov_b32 s23, 0x20000
    buffer_load_dwordx4 v[8:11], v1, s[20:23], s14 offen
    s_mov_b32 s16, s4
    s_and_b32 s17, s5, 0xffff
    s_mov_b32 s18, 1280000
    s_mov_b32 s19, 0x20000
    buffer_load_dwordx4 v[12:15], v1, s[16:19], s14 offen
    s_mov_b32 s24, s8
    s_and_b32 s25, s9, 0xffff
    s_mov_b32 s26, 2560000
    s_mov_b32 s27, 0x20000
    s_mov_b32 s28, s10
    s_and_b32 s29, s11, 0xffff
    s_mov_b32 s30, 2560000
    s_mov_b32 s31, 0x20000
    s_mov_b32 s32, s12
    s_and_b32 s33, s13, 0xffff
    s_mov_b32 s34, 6707200
    s_mov_b32 s35, 0x20000
    v_readfirstlane_b32 s47, v5
    s_barrier
    buffer_load_dwordx4 v[16:19], v2, s[24:27], s15 offen
    buffer_load_dwordx4 v[20:23], v2, s[24:27], s15 offen offset:16
    buffer_load_dwordx4 v[24:27], v2, s[28:31], s15 offen
    buffer_load_dwordx4 v[28:31], v2, s[28:31], s15 offen offset:16
    s_mov_b32 s40, 429497
    s_mov_b32 s41, 625
    s_mov_b32 s42, 6711
    v_mov_b32 v5, 1
    v_and_b32 v6, 63, v0
    v_lshlrev_b32 v6, 4, v6
    s_waitcnt vmcnt(5)
    v_mul_u32_u24 v32, s40, v8
    v_lshrrev_b32 v32, 24, v32
    v_lshlrev_b32 v36, 2, v32
    ds_add_rtn_u32 v40, v36, v5 offset:0
    v_mul_u32_u24 v33, s40, v9
    v_lshrrev_b32 v33, 24, v33
    v_lshlrev_b32 v37, 2, v33
    ds_add_rtn_u32 v41, v37, v5 offset:0
    v_mul_u32_u24 v34, s40, v10
    v_lshrrev_b32 v34, 24, v34
    v_lshlrev_b32 v38, 2, v34
    ds_add_rtn_u32 v42, v38, v5 offset:0
    v_mul_u32_u24 v35, s40, v11
    v_lshrrev_b32 v35, 24, v35
    v_lshlrev_b32 v39, 2, v35
    ds_add_rtn_u32 v43, v39, v5 offset:0
    s_waitcnt vmcnt(4)
    v_mad_u32_u24 v32, v32, s41, 15
    v_lshrrev_b32 v32, 4, v32
    v_sub_u32 v8, v8, v32
    v_mul_u32_u24 v32, s42, v12
    v_lshrrev_b32 v32, 22, v32
    v_lshl_add_u32 v8, v8, 4, v32
    v_lshl_add_u32 v12, v12, 10, v8
    v_mad_u32_u24 v33, v33, s41, 15
    v_lshrrev_b32 v33, 4, v33
    v_sub_u32 v9, v9, v33
    v_mul_u32_u24 v33, s42, v13
    v_lshrrev_b32 v33, 22, v33
    v_lshl_add_u32 v9, v9, 4, v33
    v_lshl_add_u32 v13, v13, 10, v9
    v_mad_u32_u24 v34, v34, s41, 15
    v_lshrrev_b32 v34, 4, v34
    v_sub_u32 v10, v10, v34
    v_mul_u32_u24 v34, s42, v14
    v_lshrrev_b32 v34, 22, v34
    v_lshl_add_u32 v10, v10, 4, v34
    v_lshl_add_u32 v14, v14, 10, v10
    v_mad_u32_u24 v35, v35, s41, 15
    v_lshrrev_b32 v35, 4, v35
    v_sub_u32 v11, v11, v35
    v_mul_u32_u24 v35, s42, v15
    v_lshrrev_b32 v35, 22, v35
    v_lshl_add_u32 v11, v11, 4, v35
    v_lshl_add_u32 v15, v15, 10, v11
    s_waitcnt lgkmcnt(0)
    s_barrier
    ds_read_b128 v[44:47], v6 offset:0
    s_waitcnt lgkmcnt(0)
    v_add_u32 v48, v44, v45
    v_add3_u32 v48, v48, v46, v47
    v_mov_b32 v49, v48
    s_nop 1
    v_add_u32_dpp v49, v49, v49 row_shr:1 row_mask:0xf bank_mask:0xf
    s_nop 1
    v_add_u32_dpp v49, v49, v49 row_shr:2 row_mask:0xf bank_mask:0xf
    s_nop 1
    v_add_u32_dpp v49, v49, v49 row_shr:4 row_mask:0xf bank_mask:0xf
    s_nop 1
    v_add_u32_dpp v49, v49, v49 row_shr:8 row_mask:0xf bank_mask:0xf
    s_nop 1
    v_add_u32_dpp v49, v49, v49 row_bcast:15 row_mask:0xa bank_mask:0xf
    s_nop 1
    v_add_u32_dpp v49, v49, v49 row_bcast:31 row_mask:0xc bank_mask:0xf
    v_sub_u32 v52, v49, v48
    v_add_u32 v53, v52, v44
    v_add_u32 v54, v53, v45
    v_add_u32 v55, v54, v46
    ds_write_b128 v6, v[52:55] offset:1024
    ds_read_b32 v32, v36 offset:1024
    ds_read_b32 v33, v37 offset:1024
    ds_read_b32 v34, v38 offset:1024
    ds_read_b32 v35, v39 offset:1024
    s_cmp_lg_u32 s47, 0
    s_cbranch_scc1 K1_noffs
    s_lshl_b32 s43, s2, 10
    s_add_u32 s43, s43, 6400000
    v_lshl_or_b32 v56, v44, 16, v52
    v_lshl_or_b32 v57, v45, 16, v53
    v_lshl_or_b32 v58, v46, 16, v54
    v_lshl_or_b32 v59, v47, 16, v55
    buffer_store_dwordx4 v[56:59], v6, s[32:35], s43 offen sc1
    s_waitcnt vmcnt(1) lgkmcnt(0)
    s_branch K1_go
K1_noffs:
    s_waitcnt vmcnt(0) lgkmcnt(0)
K1_go:
    v_add_u32 v32, v32, v40
    v_lshlrev_b32 v36, 4, v32
    v_add_u32 v36, 7168, v36
    v_lshlrev_b32 v32, 2, v32
    ds_write2_b64 v36, v[16:17], v[24:25] offset0:0 offset1:1
    ds_write_b32 v32, v12 offset:2048
    v_add_u32 v33, v33, v41
    v_lshlrev_b32 v37, 4, v33
    v_add_u32 v37, 7168, v37
    v_lshlrev_b32 v33, 2, v33
    ds_write2_b64 v37, v[18:19], v[26:27] offset0:0 offset1:1
    ds_write_b32 v33, v13 offset:2048
    v_add_u32 v34, v34, v42
    v_lshlrev_b32 v38, 4, v34
    v_add_u32 v38, 7168, v38
    v_lshlrev_b32 v34, 2, v34
    ds_write2_b64 v38, v[20:21], v[28:29] offset0:0 offset1:1
    ds_write_b32 v34, v14 offset:2048
    v_add_u32 v35, v35, v43
    v_lshlrev_b32 v39, 4, v35
    v_add_u32 v39, 7168, v39
    v_lshlrev_b32 v35, 2, v35
    ds_write2_b64 v39, v[22:23], v[30:31] offset0:0 offset1:1
    ds_write_b32 v35, v15 offset:2048
    s_mul_i32 s43, s2, 20480
    s_add_u32 s46, s14, 5120000
    s_waitcnt lgkmcnt(0)
    s_barrier
    ds_read_b128 v[24:27], v1 offset:2048
    ds_read_b128 v[8:11], v1 offset:7168
    ds_read_b128 v[12:15], v1 offset:12288
    ds_read_b128 v[16:19], v1 offset:17408
    ds_read_b128 v[20:23], v1 offset:22528
    s_waitcnt lgkmcnt(4)
    buffer_store_dwordx4 v[24:27], v1, s[32:35], s46 offen sc1
    s_waitcnt lgkmcnt(3)
    buffer_store_dwordx4 v[8:11], v1, s[32:35], s43 offen sc1
    s_add_u32 s43, s43, 5120
    s_waitcnt lgkmcnt(2)
    buffer_store_dwordx4 v[12:15], v1, s[32:35], s43 offen sc1
    s_add_u32 s43, s43, 5120
    s_waitcnt lgkmcnt(1)
    buffer_store_dwordx4 v[16:19], v1, s[32:35], s43 offen sc1
    s_add_u32 s43, s43, 5120
    s_waitcnt lgkmcnt(0)
    buffer_store_dwordx4 v[20:23], v1, s[32:35], s43 offen sc1
    s_add_u32 s43, s43, 5120
    s_endpgm
K1_wprep:
    s_load_dwordx4 s[4:7], s[0:1], 40
    s_load_dwordx2 s[8:9], s[0:1], 56
    s_load_dwordx2 s[12:13], s[0:1], 80
    s_sub_u32 s14, s2, 250
    s_waitcnt lgkmcnt(0)
    s_mov_b32 s16, s4
    s_and_b32 s17, s5, 0xffff
    s_mov_b32 s18, 128
    s_mov_b32 s19, 0x20000
    s_mov_b32 s20, s6
    s_and_b32 s21, s7, 0xffff
    s_mov_b32 s22, 1024
    s_mov_b32 s23, 0x20000
    s_mov_b32 s24, s8
    s_and_b32 s25, s9, 0xffff
    s_mov_b32 s26, 32768
    s_mov_b32 s27, 0x20000
    s_mov_b32 s32, s12
    s_and_b32 s33, s13, 0xffff
    s_mov_b32 s34, 6707200
    s_mov_b32 s35, 0x20000
    v_cmp_gt_u32 vcc, 256, v0
    s_and_saveexec_b64 s[36:37], vcc
    s_cbranch_execz K1_wsmall
    v_bfe_u32 v2, v0, 6, 2
    v_bfe_u32 v3, v0, 4, 2
    v_bfe_u32 v4, v0, 2, 2
    v_and_b32 v5, 3, v0
    v_lshlrev_b32 v6, 13, v2
    v_lshl_add_u32 v6, v3, 11, v6
    v_lshl_add_u32 v6, v4, 4, v6
    v_lshl_add_u32 v6, v5, 1, v6
    s_lshr_b32 s15, s14, 1
    s_lshl_b32 s15, s15, 6
    s_and_b32 s38, s14, 1
    s_lshl_b32 s38, s38, 3
    s_add_u32 s15, s15, s38
    buffer_load_ushort v16, v6, s[24:27], s15 offen offset:0
    buffer_load_ushort v17, v6, s[24:27], s15 offen offset:256
    buffer_load_ushort v18, v6, s[24:27], s15 offen offset:512
    buffer_load_ushort v19, v6, s[24:27], s15 offen offset:768
    buffer_load_ushort v20, v6, s[24:27], s15 offen offset:1024
    buffer_load_ushort v21, v6, s[24:27], s15 offen offset:1280
    buffer_load_ushort v22, v6, s[24:27], s15 offen offset:1536
    buffer_load_ushort v23, v6, s[24:27], s15 offen offset:1792
    v_lshlrev_b32 v7, 4, v0
    s_lshl_b32 s15, s14, 12
    s_add_u32 s15, s15, 6662144
    s_waitcnt vmcnt(0)
    v_lshl_or_b32 v8, v17, 16, v16
    v_lshl_or_b32 v9, v19, 16, v18
    v_lshl_or_b32 v10, v21, 16, v20
    v_lshl_or_b32 v11, v23, 16, v22
    buffer_store_dwordx4 v[8:11], v7, s[32:35], s15 offen
    s_endpgm
K1_wsmall:
    s_mov_b64 exec, s[36:37]
    v_subrev_u32 v1, 256, v0
    s_cmp_lt_u32 s14, 2
    s_cbranch_scc0 K1_wcg
    s_lshl_b32 s15, s14, 6
    v_add_u32 v1, s15, v1
    v_lshlrev_b32 v2, 1, v1
    buffer_load_ushort v8, v2, s[20:23], 0 offen offset:0
    buffer_load_ushort v9, v2, s[20:23], 0 offen offset:256
    buffer_load_ushort v10, v2, s[20:23], 0 offen offset:512
    buffer_load_ushort v11, v2, s[20:23], 0 offen offset:768
    v_and_b32 v3, 7, v1
    v_lshlrev_b32 v3, 4, v3
    v_lshrrev_b32 v4, 3, v1
    v_add_lshl_u32 v3, v3, v4, 4
    s_mov_b32 s15, 6694912
    s_waitcnt vmcnt(0)
    v_lshlrev_b32 v8, 16, v8
    v_lshlrev_b32 v9, 16, v9
    v_lshlrev_b32 v10, 16, v10
    v_lshlrev_b32 v11, 16, v11
    buffer_store_dwordx4 v[8:11], v3, s[32:35], s15 offen
    s_endpgm
K1_wcg:
    s_cmp_eq_u32 s14, 2
    s_cbranch_scc0 K1_wcode
    v_lshrrev_b32 v2, 2, v1
    v_lshlrev_b32 v2, 1, v2
    buffer_load_ushort v16, v2, s[16:19], 0 offen offset:0
    buffer_load_ushort v17, v2, s[16:19], 0 offen offset:32
    buffer_load_ushort v18, v2, s[16:19], 0 offen offset:64
    buffer_load_ushort v19, v2, s[16:19], 0 offen offset:96
    v_and_b32 v3, 1, v1
    v_lshlrev_b32 v3, 4, v3
    v_and_b32 v4, 2, v1
    v_cmp_eq_u32 vcc, 0, v4
    v_lshlrev_b32 v6, 5, v1
    s_mov_b32 s15, 6696960
    s_waitcnt vmcnt(0)
    v_lshlrev_b32 v16, v3, v16
    v_cndmask_b32 v8, 0, v16, vcc
    v_cndmask_b32 v9, v16, 0, vcc
    v_lshlrev_b32 v17, v3, v17
    v_cndmask_b32 v10, 0, v17, vcc
    v_cndmask_b32 v11, v17, 0, vcc
    v_lshlrev_b32 v18, v3, v18
    v_cndmask_b32 v12, 0, v18, vcc
    v_cndmask_b32 v13, v18, 0, vcc
    v_lshlrev_b32 v19, v3, v19
    v_cndmask_b32 v14, 0, v19, vcc
    v_cndmask_b32 v15, v19, 0, vcc
    buffer_store_dwordx4 v[8:11], v6, s[32:35], s15 offen
    buffer_store_dwordx4 v[12:15], v6, s[32:35], s15 offen offset:16
    s_endpgm
K1_wcode:
    s_cmp_eq_u32 s14, 3
    s_cbranch_scc0 K1_end
    s_getpc_b64 s[40:41]
K1_pc:
    s_add_u32 s40, s40, main_kernel-K1_pc
    s_addc_u32 s41, s41, 0
    v_lshlrev_b32 v2, 6, v1
    v_cmp_gt_u32 vcc, K2_code_end-main_kernel, v2
    s_and_b64 exec, exec, vcc
    s_cbranch_execz K1_wcode_done
    global_load_dword v8, v2, s[40:41]
    v_add_u32 v2, 4096, v2
    v_cmp_gt_u32 vcc, K2_code_end-main_kernel, v2
    s_and_b64 exec, exec, vcc
    s_cbranch_execz K1_wcode_done
    global_load_dword v9, v2, s[40:41]
    v_add_u32 v2, 4096, v2
    v_cmp_gt_u32 vcc, K2_code_end-main_kernel, v2
    s_and_b64 exec, exec, vcc
    s_cbranch_execz K1_wcode_done
    global_load_dword v10, v2, s[40:41]
    v_add_u32 v2, 4096, v2
    v_cmp_gt_u32 vcc, K2_code_end-main_kernel, v2
    s_and_b64 exec, exec, vcc
    s_cbranch_execz K1_wcode_done
    global_load_dword v11, v2, s[40:41]
    v_add_u32 v2, 4096, v2
K1_wcode_done:
    s_waitcnt vmcnt(0)
K1_end:
    s_endpgm
.globl main_kernel
.p2align 8
.type main_kernel,@function
main_kernel:
    s_cmp_ge_u32 s2, 256
    s_cbranch_scc1 K2_end
    s_load_dwordx2 s[4:5], s[0:1], 0
    s_load_dwordx2 s[6:7], s[0:1], 80
    s_load_dwordx2 s[62:63], s[0:1], 64
    s_and_b32 s3, s2, 7
    s_lshl_b32 s3, s3, 5
    s_lshr_b32 s39, s2, 3
    s_add_u32 s39, s39, s3
    v_mov_b32 v23, v0
    v_and_b32 v22, 63, v0
    v_lshrrev_b32 v1, 6, v0
    v_lshlrev_b32 v2, 2, v0
    v_mov_b32 v3, 0
    v_readfirstlane_b32 s20, v1
    v_cmp_gt_u32 vcc, 164, v0
    s_and_saveexec_b64 s[60:61], vcc
    ds_write_b32 v2, v3 offset:51360
    s_mov_b64 exec, s[60:61]
    v_lshrrev_b32 v8, 1, v0
    v_and_b32 v9, 1, v0
    v_lshlrev_b32 v10, 10, v8
    s_lshl_b32 s3, s39, 2
    s_add_u32 s3, s3, 6400000
    s_waitcnt lgkmcnt(0)
    s_mov_b32 s12, s6
    s_and_b32 s13, s7, 0xffff
    s_mov_b32 s14, 6707200
    s_mov_b32 s15, 0x20000
    buffer_load_dword v12, v10, s[12:15], s3 offen
    s_lshl_b32 s3, s20, 8
    s_add_u32 s3, s3, 91648
    s_mov_b32 m0, s3
    s_mov_b32 s3, 6694912
    buffer_load_dword v2, s[12:15], s3 offen lds
    s_mov_b32 s8, s4
    s_and_b32 s9, s5, 0xffff
    s_mov_b32 s10, 10240000
    s_mov_b32 s11, 0x20000
    s_mov_b32 s16, s62
    s_and_b32 s17, s63, 0xffff
    s_mov_b32 s18, 10240000
    s_mov_b32 s19, 0x20000
    s_getpc_b64 s[4:5]
K2_pc:
    v_lshlrev_b32 v14, 7, v23
    v_cmp_gt_u32 vcc, K2_code_end-K2_pc, v14
    s_and_saveexec_b64 s[60:61], vcc
    s_cbranch_execz K2_nocpf
    global_load_dword v15, v14, s[4:5]
K2_nocpf:
    s_mov_b64 exec, s[60:61]
    s_barrier
    v_mov_b32 v16, 0
    v_mov_b32 v17, 0
    v_mov_b32 v18, 0
    v_mov_b32 v19, 0
    s_nop 1
    v_mfma_f32_32x32x16_bf16 v[96:111], v[16:19], v[16:19], 0
    v_mfma_f32_32x32x16_bf16 v[112:127], v[16:19], v[16:19], 0
    v_mfma_f32_32x32x16_bf16 v[128:143], v[16:19], v[16:19], 0
    v_mfma_f32_32x32x16_bf16 v[144:159], v[16:19], v[16:19], 0
    v_mfma_f32_32x32x16_bf16 v[160:175], v[16:19], v[16:19], 0
    v_mfma_f32_32x32x16_bf16 v[176:191], v[16:19], v[16:19], 0
    v_mfma_f32_32x32x16_bf16 v[192:207], v[16:19], v[16:19], 0
    v_mfma_f32_32x32x16_bf16 v[208:223], v[16:19], v[16:19], 0
    v_mfma_f32_32x32x16_bf16 v[224:239], v[16:19], v[16:19], 0
    v_mfma_f32_32x32x16_bf16 v[240:255], v[16:19], v[16:19], 0
    v_and_b32 v4, 15, v23
    v_lshlrev_b32 v4, 4, v4
    v_lshrrev_b32 v3, 4, v22
    v_mul_u32_u24 v0, 0x0202, v3
    v_add_u32 v0, 0x0100, v0
    v_lshlrev_b32 v0, 16, v0
    v_or_b32 v0, 0x0c0c, v0
    v_and_b32 v7, 7, v22
    v_and_b32 v2, 1, v7
    v_mul_u32_u24 v2, 7, v2
    v_xor_b32 v2, s20, v2
    v_lshl_add_u32 v2, v7, 3, v2
    v_lshlrev_b32 v2, 2, v2
    v_and_b32 v6, 1, v3
    v_mul_u32_u24 v6, 7, v6
    v_xor_b32 v6, s20, v6
    v_lshl_add_u32 v6, v3, 3, v6
    v_lshlrev_b32 v6, 2, v6
    s_lshl_b32 s3, s20, 2
    s_add_u32 s3, s3, 128
    v_mov_b32 v1, s3
    s_mov_b32 s21, 0x05040100
    s_mov_b32 s22, 0x07060302
    s_mov_b32 s36, 0
    v_mul_u32_u24 v10, 1280, v8
    v_add_u32 v10, v10, v9
    v_lshlrev_b32 v16, 5, v22
    v_cmp_gt_u32 vcc, 250, v8
    s_waitcnt vmcnt(0)
    v_lshrrev_b32 v11, 16, v12
    v_and_b32 v12, 0xffff, v12
    v_cndmask_b32 v11, 0, v11, vcc
    v_add_u32 v10, v10, v12
    v_sub_u32 v13, v11, v9
    v_lshlrev_b32 v14, 4, v10
    v_lshlrev_b32 v10, 2, v10
    s_mov_b32 s3, 5120000
    v_cmp_lt_i32 s[40:41], 0, v13
    v_cmp_lt_i32 s[42:43], 2, v13
    v_cmp_lt_i32 s[44:45], 4, v13
    v_cmp_lt_i32 s[46:47], 6, v13
    v_cmp_lt_i32 s[48:49], 8, v13
    v_cmp_lt_i32 s[50:51], 10, v13
    v_cmp_lt_i32 s[52:53], 12, v13
    v_cmp_lt_i32 s[54:55], 14, v13
    v_cmp_lt_i32 s[56:57], 16, v13
    v_cmp_lt_i32 s[58:59], 18, v13
    s_mov_b64 exec, s[40:41]
    s_cbranch_execz K2_lt_done
    buffer_load_dword v72, v10, s[12:15], s3 offen offset:0
    s_mov_b64 exec, s[42:43]
    s_cbranch_execz K2_lt_done
    buffer_load_dword v73, v10, s[12:15], s3 offen offset:8
    s_mov_b64 exec, s[44:45]
    s_cbranch_execz K2_lt_done
    buffer_load_dword v74, v10, s[12:15], s3 offen offset:16
    s_mov_b64 exec, s[46:47]
    s_cbranch_execz K2_lt_done
    buffer_load_dword v75, v10, s[12:15], s3 offen offset:24
    s_mov_b64 exec, s[48:49]
    s_cbranch_execz K2_lt_done
    buffer_load_dword v76, v10, s[12:15], s3 offen offset:32
    s_mov_b64 exec, s[50:51]
    s_cbranch_execz K2_lt_done
    buffer_load_dword v77, v10, s[12:15], s3 offen offset:40
    s_mov_b64 exec, s[52:53]
    s_cbranch_execz K2_lt_done
    buffer_load_dword v78, v10, s[12:15], s3 offen offset:48
    s_mov_b64 exec, s[54:55]
    s_cbranch_execz K2_lt_done
    buffer_load_dword v79, v10, s[12:15], s3 offen offset:56
    s_mov_b64 exec, s[56:57]
    s_cbranch_execz K2_lt_done
    buffer_load_dword v80, v10, s[12:15], s3 offen offset:64
    s_mov_b64 exec, s[58:59]
    s_cbranch_execz K2_lt_done
    buffer_load_dword v81, v10, s[12:15], s3 offen offset:72
K2_lt_done:
    s_mov_b64 exec, -1
    v_cmp_lt_u32 s[60:61], 20, v11
    v_mov_b32 v17, 1
    s_mov_b32 s3, 6696960
    s_mov_b64 exec, s[40:41]
    s_cbranch_execz K2_lp0
    buffer_load_dwordx4 v[32:35], v14, s[12:15], 0 offen offset:0
    s_mov_b64 exec, s[42:43]
    s_cbranch_execz K2_lp1
    buffer_load_dwordx4 v[36:39], v14, s[12:15], 0 offen offset:32
    s_mov_b64 exec, s[44:45]
    s_cbranch_execz K2_lp2
    buffer_load_dwordx4 v[40:43], v14, s[12:15], 0 offen offset:64
    s_mov_b64 exec, s[46:47]
    s_cbranch_execz K2_lp3
    buffer_load_dwordx4 v[44:47], v14, s[12:15], 0 offen offset:96
    s_mov_b64 exec, s[48:49]
    s_cbranch_execz K2_lp4
    buffer_load_dwordx4 v[48:51], v14, s[12:15], 0 offen offset:128
    s_mov_b64 exec, s[50:51]
    s_cbranch_execz K2_lp5
    buffer_load_dwordx4 v[52:55], v14, s[12:15], 0 offen offset:160
    s_mov_b64 exec, s[52:53]
    s_cbranch_execz K2_lp6
    buffer_load_dwordx4 v[56:59], v14, s[12:15], 0 offen offset:192
    s_mov_b64 exec, s[54:55]
    s_cbranch_execz K2_lp7
    buffer_load_dwordx4 v[60:63], v14, s[12:15], 0 offen offset:224
    s_mov_b64 exec, s[56:57]
    s_cbranch_execz K2_lp8
    buffer_load_dwordx4 v[64:67], v14, s[12:15], 0 offen offset:256
    s_mov_b64 exec, s[58:59]
    s_cbranch_execz K2_lp9
    buffer_load_dwordx4 v[68:71], v14, s[12:15], 0 offen offset:288
    s_waitcnt vmcnt(10)
K2_ld_done:
    s_mov_b64 exec, s[40:41]
    s_cbranch_execz K2_h_done
    v_and_b32 v9, 0x3fc, v72
    v_lshlrev_b32 v8, 3, v72
    v_lshlrev_b32 v8, v8, v17
    ds_add_rtn_u32 v82, v9, v8 offset:51360
    s_mov_b64 exec, s[42:43]
    s_cbranch_execz K2_h_done
    v_and_b32 v9, 0x3fc, v73
    v_lshlrev_b32 v8, 3, v73
    v_lshlrev_b32 v8, v8, v17
    ds_add_rtn_u32 v83, v9, v8 offset:51360
    s_mov_b64 exec, s[44:45]
    s_cbranch_execz K2_h_done
    v_and_b32 v9, 0x3fc, v74
    v_lshlrev_b32 v8, 3, v74
    v_lshlrev_b32 v8, v8, v17
    ds_add_rtn_u32 v84, v9, v8 offset:51360
    s_mov_b64 exec, s[46:47]
    s_cbranch_execz K2_h_done
    v_and_b32 v9, 0x3fc, v75
    v_lshlrev_b32 v8, 3, v75
    v_lshlrev_b32 v8, v8, v17
    ds_add_rtn_u32 v85, v9, v8 offset:51360
    s_mov_b64 exec, s[48:49]
    s_cbranch_execz K2_h_done
    v_and_b32 v9, 0x3fc, v76
    v_lshlrev_b32 v8, 3, v76
    v_lshlrev_b32 v8, v8, v17
    ds_add_rtn_u32 v86, v9, v8 offset:51360
    s_mov_b64 exec, s[50:51]
    s_cbranch_execz K2_h_done
    v_and_b32 v9, 0x3fc, v77
    v_lshlrev_b32 v8, 3, v77
    v_lshlrev_b32 v8, v8, v17
    ds_add_rtn_u32 v87, v9, v8 offset:51360
    s_mov_b64 exec, s[52:53]
    s_cbranch_execz K2_h_done
    v_and_b32 v9, 0x3fc, v78
    v_lshlrev_b32 v8, 3, v78
    v_lshlrev_b32 v8, v8, v17
    ds_add_rtn_u32 v88, v9, v8 offset:51360
    s_mov_b64 exec, s[54:55]
    s_cbranch_execz K2_h_done
    v_and_b32 v9, 0x3fc, v79
    v_lshlrev_b32 v8, 3, v79
    v_lshlrev_b32 v8, v8, v17
    ds_add_rtn_u32 v89, v9, v8 offset:51360
    s_mov_b64 exec, s[56:57]
    s_cbranch_execz K2_h_done
    v_and_b32 v9, 0x3fc, v80
    v_lshlrev_b32 v8, 3, v80
    v_lshlrev_b32 v8, v8, v17
    ds_add_rtn_u32 v90, v9, v8 offset:51360
    s_mov_b64 exec, s[58:59]
    s_cbranch_execz K2_h_done
    v_and_b32 v9, 0x3fc, v81
    v_lshlrev_b32 v8, 3, v81
    v_lshlrev_b32 v8, v8, v17
    ds_add_rtn_u32 v91, v9, v8 offset:51360
K2_h_done:
    s_mov_b64 exec, -1
    buffer_load_dwordx4 v[24:27], v16, s[12:15], s3 offen
    buffer_load_dwordx4 v[28:31], v16, s[12:15], s3 offen offset:16
    s_waitcnt lgkmcnt(0)
    s_mov_b64 exec, s[40:41]
    s_cbranch_execz K2_r_done
    v_lshlrev_b32 v8, 3, v72
    v_bfe_u32 v82, v82, v8, 8
    v_and_b32 v8, 0x3f0, v72
    v_cmp_lt_u32 vcc, 63, v82
    v_lshl_add_u32 v82, v8, 2, v82
    s_or_b64 s[60:61], s[60:61], vcc
    s_mov_b64 exec, s[42:43]
    s_cbranch_execz K2_r_done
    v_lshlrev_b32 v8, 3, v73
    v_bfe_u32 v83, v83, v8, 8
    v_and_b32 v8, 0x3f0, v73
    v_cmp_lt_u32 vcc, 63, v83
    v_lshl_add_u32 v83, v8, 2, v83
    s_or_b64 s[60:61], s[60:61], vcc
    s_mov_b64 exec, s[44:45]
    s_cbranch_execz K2_r_done
    v_lshlrev_b32 v8, 3, v74
    v_bfe_u32 v84, v84, v8, 8
    v_and_b32 v8, 0x3f0, v74
    v_cmp_lt_u32 vcc, 63, v84
    v_lshl_add_u32 v84, v8, 2, v84
    s_or_b64 s[60:61], s[60:61], vcc
    s_mov_b64 exec, s[46:47]
    s_cbranch_execz K2_r_done
    v_lshlrev_b32 v8, 3, v75
    v_bfe_u32 v85, v85, v8, 8
    v_and_b32 v8, 0x3f0, v75
    v_cmp_lt_u32 vcc, 63, v85
    v_lshl_add_u32 v85, v8, 2, v85
    s_or_b64 s[60:61], s[60:61], vcc
    s_mov_b64 exec, s[48:49]
    s_cbranch_execz K2_r_done
    v_lshlrev_b32 v8, 3, v76
    v_bfe_u32 v86, v86, v8, 8
    v_and_b32 v8, 0x3f0, v76
    v_cmp_lt_u32 vcc, 63, v86
    v_lshl_add_u32 v86, v8, 2, v86
    s_or_b64 s[60:61], s[60:61], vcc
    s_mov_b64 exec, s[50:51]
    s_cbranch_execz K2_r_done
    v_lshlrev_b32 v8, 3, v77
    v_bfe_u32 v87, v87, v8, 8
    v_and_b32 v8, 0x3f0, v77
    v_cmp_lt_u32 vcc, 63, v87
    v_lshl_add_u32 v87, v8, 2, v87
    s_or_b64 s[60:61], s[60:61], vcc
    s_mov_b64 exec, s[52:53]
    s_cbranch_execz K2_r_done
    v_lshlrev_b32 v8, 3, v78
    v_bfe_u32 v88, v88, v8, 8
    v_and_b32 v8, 0x3f0, v78
    v_cmp_lt_u32 vcc, 63, v88
    v_lshl_add_u32 v88, v8, 2, v88
    s_or_b64 s[60:61], s[60:61], vcc
    s_mov_b64 exec, s[54:55]
    s_cbranch_execz K2_r_done
    v_lshlrev_b32 v8, 3, v79
    v_bfe_u32 v89, v89, v8, 8
    v_and_b32 v8, 0x3f0, v79
    v_cmp_lt_u32 vcc, 63, v89
    v_lshl_add_u32 v89, v8, 2, v89
    s_or_b64 s[60:61], s[60:61], vcc
    s_mov_b64 exec, s[56:57]
    s_cbranch_execz K2_r_done
    v_lshlrev_b32 v8, 3, v80
    v_bfe_u32 v90, v90, v8, 8
    v_and_b32 v8, 0x3f0, v80
    v_cmp_lt_u32 vcc, 63, v90
    v_lshl_add_u32 v90, v8, 2, v90
    s_or_b64 s[60:61], s[60:61], vcc
    s_mov_b64 exec, s[58:59]
    s_cbranch_execz K2_r_done
    v_lshlrev_b32 v8, 3, v81
    v_bfe_u32 v91, v91, v8, 8
    v_and_b32 v8, 0x3f0, v81
    v_cmp_lt_u32 vcc, 63, v91
    v_lshl_add_u32 v91, v8, 2, v91
    s_or_b64 s[60:61], s[60:61], vcc
K2_r_done:
    s_mov_b64 exec, -1
    v_mov_b32 v9, 52000
    s_cmp_eq_u64 s[60:61], 0
    s_cbranch_scc1 K2_noflag
    ds_write_b32 v9, v17
K2_noflag:
    v_lshlrev_b32 v8, 4, v22
    s_waitcnt lgkmcnt(0)
    s_barrier
    ds_read_b128 v[12:15], v8 offset:51360
    ds_read_b32 v9, v9
    v_lshlrev_b32 v5, 4, v23
    s_mul_i32 s5, s20, 5440
    s_add_u32 s5, s5, 93696
    s_mov_b32 m0, s5
    s_lshl_b32 s5, s39, 13
    s_add_u32 s5, s5, 0
    buffer_load_dwordx4 v5, s[8:11], s5 offen lds
    s_mul_i32 s5, s20, 5440
    s_add_u32 s5, s5, 93696
    s_mov_b32 m0, s5
    s_lshl_b32 s5, s39, 13
    s_add_u32 s5, s5, 2097152
    buffer_load_dwordx4 v5, s[8:11], s5 offen lds
    s_waitcnt lgkmcnt(0)
    s_mov_b32 s3, 0x01010101
    v_mov_b32 v10, 0
    v_lshlrev_b32 v18, 8, v12
    v_lshl_add_u32 v18, v12, 16, v18
    v_lshl_add_u32 v18, v12, 24, v18
    v_sad_u8 v10, v12, 0, v10
    v_lshlrev_b32 v19, 8, v13
    v_lshl_add_u32 v19, v13, 16, v19
    v_lshl_add_u32 v19, v13, 24, v19
    v_mul_lo_u32 v11, v10, s3
    v_add_u32 v19, v19, v11
    v_sad_u8 v10, v13, 0, v10
    v_lshlrev_b32 v20, 8, v14
    v_lshl_add_u32 v20, v14, 16, v20
    v_lshl_add_u32 v20, v14, 24, v20
    v_mul_lo_u32 v11, v10, s3
    v_add_u32 v20, v20, v11
    v_sad_u8 v10, v14, 0, v10
    v_lshlrev_b32 v21, 8, v15
    v_lshl_add_u32 v21, v15, 16, v21
    v_lshl_add_u32 v21, v15, 24, v21
    v_mul_lo_u32 v11, v10, s3
    v_add_u32 v21, v21, v11
    v_sad_u8 v10, v15, 0, v10
    v_cmp_gt_u32 vcc, 40, v22
    s_and_saveexec_b64 s[60:61], vcc
    ds_write_b128 v8, v[18:21] offset:52016
    v_cmp_lt_u32 vcc, 64, v10
    s_mov_b64 exec, s[60:61]
    v_readfirstlane_b32 s3, v9
    s_cmp_lg_u64 vcc, 0
    s_cbranch_scc1 K2_slow
    s_cmp_lg_u32 s3, 0
    s_cbranch_scc1 K2_slow
    s_mov_b64 exec, s[40:41]
    s_cbranch_execz K2_p_done
    v_and_b32 v8, 0x3ff, v72
    ds_read_u8 v12, v8 offset:52016
    s_mov_b64 exec, s[42:43]
    s_cbranch_execz K2_p_done
    v_and_b32 v8, 0x3ff, v73
    ds_read_u8 v13, v8 offset:52016
    s_mov_b64 exec, s[44:45]
    s_cbranch_execz K2_p_done
    v_and_b32 v8, 0x3ff, v74
    ds_read_u8 v14, v8 offset:52016
    s_mov_b64 exec, s[46:47]
    s_cbranch_execz K2_p_done
    v_and_b32 v8, 0x3ff, v75
    ds_read_u8 v15, v8 offset:52016
    s_mov_b64 exec, s[48:49]
    s_cbranch_execz K2_p_done
    v_and_b32 v8, 0x3ff, v76
    ds_read_u8 v16, v8 offset:52016
    s_mov_b64 exec, s[50:51]
    s_cbranch_execz K2_p_done
    v_and_b32 v8, 0x3ff, v77
    ds_read_u8 v17, v8 offset:52016
    s_mov_b64 exec, s[52:53]
    s_cbranch_execz K2_p_done
    v_and_b32 v8, 0x3ff, v78
    ds_read_u8 v18, v8 offset:52016
    s_mov_b64 exec, s[54:55]
    s_cbranch_execz K2_p_done
    v_and_b32 v8, 0x3ff, v79
    ds_read_u8 v19, v8 offset:52016
    s_mov_b64 exec, s[56:57]
    s_cbranch_execz K2_p_done
    v_and_b32 v8, 0x3ff, v80
    ds_read_u8 v20, v8 offset:52016
    s_mov_b64 exec, s[58:59]
    s_cbranch_execz K2_p_done
    v_and_b32 v8, 0x3ff, v81
    ds_read_u8 v21, v8 offset:52016
K2_p_done:
    s_mov_b64 exec, -1
    s_mul_i32 s5, s20, 5440
    s_add_u32 s5, s5, 93696
    s_mov_b32 m0, s5
    s_lshl_b32 s5, s39, 13
    s_add_u32 s5, s5, 4194304
    buffer_load_dwordx4 v5, s[8:11], s5 offen lds
    v_add_u32 v8, 3, v10
    v_lshrrev_b32 v8, 2, v8
    v_subrev_u32 v8, 5, v8
    v_med3_i32 v8, v8, 0, 7
    v_cmp_gt_u32 vcc, 40, v22
    v_mov_b32 v9, 63
    s_nop 0
    v_cndmask_b32 v8, 64, v8, vcc
    v_cmp_eq_u32 s[24:25], 0, v8
    v_cmp_eq_u32 s[26:27], 1, v8
    v_cmp_eq_u32 s[28:29], 2, v8
    v_cmp_eq_u32 s[30:31], 3, v8
    v_cmp_eq_u32 s[32:33], 4, v8
    v_cmp_eq_u32 s[82:83], 5, v8
    v_cmp_eq_u32 s[84:85], 6, v8
    v_cmp_eq_u32 s[86:87], 7, v8
    s_waitcnt vmcnt(3) lgkmcnt(0)
    s_mov_b64 exec, s[40:41]
    s_cbranch_execz K2_s_done
    v_add_lshl_u32 v8, v82, v12, 2
    v_lshlrev_b32 v11, 2, v8
    v_and_b32 v72, 0xfffc00, v72
    ds_write_b128 v11, v[32:35] offset:0
    ds_write_b32 v8, v72 offset:41088
    s_mov_b64 exec, s[42:43]
    s_cbranch_execz K2_s_done
    v_add_lshl_u32 v8, v83, v13, 2
    v_lshlrev_b32 v11, 2, v8
    v_and_b32 v73, 0xfffc00, v73
    ds_write_b128 v11, v[36:39] offset:0
    ds_write_b32 v8, v73 offset:41088
    s_mov_b64 exec, s[44:45]
    s_cbranch_execz K2_s_done
    v_add_lshl_u32 v8, v84, v14, 2
    v_lshlrev_b32 v11, 2, v8
    v_and_b32 v74, 0xfffc00, v74
    ds_write_b128 v11, v[40:43] offset:0
    ds_write_b32 v8, v74 offset:41088
    s_mov_b64 exec, s[46:47]
    s_cbranch_execz K2_s_done
    v_add_lshl_u32 v8, v85, v15, 2
    v_lshlrev_b32 v11, 2, v8
    v_and_b32 v75, 0xfffc00, v75
    ds_write_b128 v11, v[44:47] offset:0
    ds_write_b32 v8, v75 offset:41088
    s_mov_b64 exec, s[48:49]
    s_cbranch_execz K2_s_done
    v_add_lshl_u32 v8, v86, v16, 2
    v_lshlrev_b32 v11, 2, v8
    v_and_b32 v76, 0xfffc00, v76
    ds_write_b128 v11, v[48:51] offset:0
    ds_write_b32 v8, v76 offset:41088
    s_mov_b64 exec, s[50:51]
    s_cbranch_execz K2_s_done
    v_add_lshl_u32 v8, v87, v17, 2
    v_lshlrev_b32 v11, 2, v8
    v_and_b32 v77, 0xfffc00, v77
    ds_write_b128 v11, v[52:55] offset:0
    ds_write_b32 v8, v77 offset:41088
    s_mov_b64 exec, s[52:53]
    s_cbranch_execz K2_s_done
    v_add_lshl_u32 v8, v88, v18, 2
    v_lshlrev_b32 v11, 2, v8
    v_and_b32 v78, 0xfffc00, v78
    ds_write_b128 v11, v[56:59] offset:0
    ds_write_b32 v8, v78 offset:41088
    s_mov_b64 exec, s[54:55]
    s_cbranch_execz K2_s_done
    v_add_lshl_u32 v8, v89, v19, 2
    v_lshlrev_b32 v11, 2, v8
    v_and_b32 v79, 0xfffc00, v79
    ds_write_b128 v11, v[60:63] offset:0
    ds_write_b32 v8, v79 offset:41088
    s_mov_b64 exec, s[56:57]
    s_cbranch_execz K2_s_done
    v_add_lshl_u32 v8, v90, v20, 2
    v_lshlrev_b32 v11, 2, v8
    v_and_b32 v80, 0xfffc00, v80
    ds_write_b128 v11, v[64:67] offset:0
    ds_write_b32 v8, v80 offset:41088
    s_mov_b64 exec, s[58:59]
    s_cbranch_execz K2_s_done
    v_add_lshl_u32 v8, v91, v21, 2
    v_lshlrev_b32 v11, 2, v8
    v_and_b32 v81, 0xfffc00, v81
    ds_write_b128 v11, v[68:71] offset:0
    ds_write_b32 v8, v81 offset:41088
K2_s_done:
    s_mov_b32 s3, 0
    s_mov_b64 exec, s[86:87]
    v_mbcnt_lo_u32_b32 v9, s86, 0
    v_mbcnt_hi_u32_b32 v9, s87, v9
    v_add_u32 v9, s3, v9
    s_bcnt1_i32_b64 s4, s[86:87]
    s_add_u32 s3, s3, s4
    s_mov_b64 exec, s[84:85]
    v_mbcnt_lo_u32_b32 v9, s84, 0
    v_mbcnt_hi_u32_b32 v9, s85, v9
    v_add_u32 v9, s3, v9
    s_bcnt1_i32_b64 s4, s[84:85]
    s_add_u32 s3, s3, s4
    s_mov_b64 exec, s[82:83]
    v_mbcnt_lo_u32_b32 v9, s82, 0
    v_mbcnt_hi_u32_b32 v9, s83, v9
    v_add_u32 v9, s3, v9
    s_bcnt1_i32_b64 s4, s[82:83]
    s_add_u32 s3, s3, s4
    s_mov_b64 exec, s[32:33]
    v_mbcnt_lo_u32_b32 v9, s32, 0
    v_mbcnt_hi_u32_b32 v9, s33, v9
    v_add_u32 v9, s3, v9
    s_bcnt1_i32_b64 s4, s[32:33]
    s_add_u32 s3, s3, s4
    s_mov_b64 exec, s[30:31]
    v_mbcnt_lo_u32_b32 v9, s30, 0
    v_mbcnt_hi_u32_b32 v9, s31, v9
    v_add_u32 v9, s3, v9
    s_bcnt1_i32_b64 s4, s[30:31]
    s_add_u32 s3, s3, s4
    s_mov_b64 exec, s[28:29]
    v_mbcnt_lo_u32_b32 v9, s28, 0
    v_mbcnt_hi_u32_b32 v9, s29, v9
    v_add_u32 v9, s3, v9
    s_bcnt1_i32_b64 s4, s[28:29]
    s_add_u32 s3, s3, s4
    s_mov_b64 exec, s[26:27]
    v_mbcnt_lo_u32_b32 v9, s26, 0
    v_mbcnt_hi_u32_b32 v9, s27, v9
    v_add_u32 v9, s3, v9
    s_bcnt1_i32_b64 s4, s[26:27]
    s_add_u32 s3, s3, s4
    s_mov_b64 exec, s[24:25]
    v_mbcnt_lo_u32_b32 v9, s24, 0
    v_mbcnt_hi_u32_b32 v9, s25, v9
    v_add_u32 v9, s3, v9
    s_bcnt1_i32_b64 s4, s[24:25]
    s_add_u32 s3, s3, s4
    s_mov_b64 exec, -1
    v_lshlrev_b32 v9, 2, v9
    v_lshl_add_u32 v8, v10, 8, v22
    ds_permute_b32 v8, v9, v8
    s_mul_i32 s5, s20, 5440
    s_add_u32 s5, s5, 93696
    s_mov_b32 m0, s5
    s_lshl_b32 s5, s39, 13
    s_add_u32 s5, s5, 6291456
    buffer_load_dwordx4 v5, s[8:11], s5 offen lds
    s_mul_i32 s5, s20, 5440
    s_add_u32 s5, s5, 93696
    s_mov_b32 m0, s5
    s_lshl_b32 s5, s39, 13
    s_add_u32 s5, s5, 8388608
    buffer_load_dwordx4 v5, s[8:11], s5 offen lds
    s_waitcnt lgkmcnt(0)
    ds_bpermute_b32 v11, v2, v8
    ds_bpermute_b32 v6, v6, v8
    ds_bpermute_b32 v1, v1, v8
    v_mov_b32 v12, 0
    v_mov_b32 v13, 0
    s_mov_b32 s35, 0
K2_sched:
    v_and_b32 v14, 15, v22
    s_lshl_b32 s3, s20, 6
    v_lshl_add_u32 v15, v7, 2, s3
    s_waitcnt lgkmcnt(0)
    ds_write_b32 v15, v11 offset:53168
    v_and_b32 v17, 0xff, v6
    v_lshl_add_u32 v17, v17, 4, v14
    ds_read_u8 v17, v17 offset:52017
    v_lshrrev_b32 v16, 8, v6
    v_add_u32 v16, 3, v16
    v_lshrrev_b32 v16, 2, v16
    v_and_b32 v20, 0xff, v1
    v_lshl_add_u32 v20, v20, 4, v14
    ds_read_u8 v20, v20 offset:52017
    v_lshrrev_b32 v19, 8, v1
    v_add_u32 v19, 3, v19
    v_lshrrev_b32 v19, 2, v19
    s_cmp_eq_u32 s35, 0
    s_cselect_b32 s4, 15, 0
    v_cmp_le_u32 vcc, s4, v14
    s_waitcnt lgkmcnt(0)
    v_add_u32 v17, 1, v17
    v_lshrrev_b32 v17, 2, v17
    v_cndmask_b32 v17, v17, v16, vcc
    v_sub_u32 v17, v17, v14
    v_add_u32 v18, 1, v12
    v_min_i32 v17, v17, v18
    v_add_u32 v20, 1, v20
    v_lshrrev_b32 v20, 2, v20
    v_cndmask_b32 v20, v20, v19, vcc
    v_sub_u32 v20, v20, v14
    v_add_u32 v21, 1, v13
    v_min_i32 v20, v20, v21
    s_nop 0
    v_min_i32_dpp v17, v17, v17 row_shr:1 row_mask:0xf bank_mask:0xf
    v_min_i32_dpp v20, v20, v20 row_shr:1 row_mask:0xf bank_mask:0xf
    s_nop 0
    v_min_i32_dpp v17, v17, v17 row_shr:2 row_mask:0xf bank_mask:0xf
    v_min_i32_dpp v20, v20, v20 row_shr:2 row_mask:0xf bank_mask:0xf
    s_nop 0
    v_min_i32_dpp v17, v17, v17 row_shr:4 row_mask:0xf bank_mask:0xf
    v_min_i32_dpp v20, v20, v20 row_shr:4 row_mask:0xf bank_mask:0xf
    s_nop 0
    v_min_i32_dpp v17, v17, v17 row_shr:8 row_mask:0xf bank_mask:0xf
    v_min_i32_dpp v20, v20, v20 row_shr:8 row_mask:0xf bank_mask:0xf
    v_subrev_u32 v18, 15, v16
    v_max_i32 v17, v17, v18
    v_subrev_u32 v21, 15, v19
    v_max_i32 v20, v20, v21
    v_add_u32 v18, v17, v14
    v_add_u32 v21, v20, v14
    s_nop 0
    v_mov_b32_dpp v12, v18 row_shr:1 row_mask:0xf bank_mask:0xf
    v_mov_b32_dpp v13, v21 row_shr:1 row_mask:0xf bank_mask:0xf
    s_lshl_b32 s4, s20, 7
    v_lshl_add_u32 v15, v14, 3, s4
    v_sub_u32 v17, v18, v12
    v_lshl_or_b32 v17, v17, 7, v12
    v_add_u32 v6, v15, v3
    ds_write_b8 v6, v17 offset:53680
    v_sub_u32 v20, v21, v13
    v_lshl_or_b32 v20, v20, 7, v13
    ds_write_b8 v15, v20 offset:53684
    v_add_u32 v15, s4, v22
    ds_read_u8 v12, v15 offset:53680
    ds_read_u8 v13, v15 offset:53744
    v_and_b32 v16, 0xff, v11
    v_lshlrev_b32 v16, 6, v16
    v_lshrrev_b32 v10, 8, v11
    v_cmp_gt_u32 vcc, 5, v7
    v_mov_b32 v20, 0
    v_mov_b32 v21, 0
    v_cndmask_b32 v10, 0, v10, vcc
    s_waitcnt lgkmcnt(0)
    v_cndmask_b32 v12, 0, v12, vcc
    v_cndmask_b32 v13, 0, v13, vcc
    v_cmp_lt_u32 s[24:25], 64, v12
    v_cmp_lt_u32 s[26:27], 64, v13
    v_and_b32 v12, 0x7f, v12
    v_and_b32 v13, 0x7f, v13
    v_lshl_add_u32 v12, v12, 2, v16
    v_lshl_add_u32 v13, v13, 2, v16
    s_bcnt1_i32_b64 s4, s[24:25]
    s_bcnt1_i32_b64 s31, s[26:27]
    s_add_u32 s31, s31, s4
    s_lshl_b32 s5, s20, 7
    s_add_u32 s4, s4, s5
    v_mbcnt_lo_u32_b32 v17, s24, 0
    v_mbcnt_hi_u32_b32 v17, s25, v17
    v_mbcnt_lo_u32_b32 v18, s26, 0
    v_mbcnt_hi_u32_b32 v18, s27, v18
    v_add_lshl_u32 v17, s5, v17, 2
    v_add_lshl_u32 v18, s4, v18, 2
    v_add_lshl_u32 v19, s5, v22, 2
    v_mov_b32 v15, 2560
    ds_write_b32 v19, v15 offset:54704
    ds_write_b32 v19, v15 offset:54960
    s_mov_b64 exec, s[24:25]
    ds_write_b32 v17, v12 offset:54704
    s_mov_b64 exec, s[26:27]
    ds_write_b32 v18, v13 offset:54704
    s_mov_b64 exec, -1
    v_and_b32 v1, 3, v22
    v_add_lshl_u32 v1, s5, v1, 2
    ds_read_b32 v12, v1 offset:54704
    ds_read_b32 v2, v1 offset:54720
    v_lshrrev_b32 v14, 3, v22
    v_add_u32 v15, 3, v10
    v_and_b32 v15, 0xfc, v15
    v_add_u32 v14, v10, v14
    v_cmp_lt_u32 vcc, v14, v15
    v_add_u32 v14, v16, v14
    v_add_u32 v15, 2560, v7
    v_subrev_u32 v19, 24, v22
    v_cmp_gt_u32 s[60:61], 4, v19
    v_bfe_u32 v7, v22, 2, 2
    v_mov_b32 v22, 0
    v_mov_b32 v23, 0
    v_cndmask_b32 v14, v14, v15, s[60:61]
    s_or_b64 exec, vcc, s[60:61]
    v_lshlrev_b32 v15, 4, v14
    v_lshlrev_b32 v14, 2, v14
    v_mov_b32 v19, 2130706432
    ds_write_b128 v15, v[20:23] offset:0
    ds_write_b32 v14, v19 offset:41088
    s_mov_b64 exec, -1
    s_waitcnt lgkmcnt(0)
    s_barrier
    s_cmp_lg_u32 s35, 0
    s_cbranch_scc1 K2_nobg
K2_nobg:
    v_readlane_b32 s4, v12, 0
    v_readlane_b32 s5, v12, 1
    v_readlane_b32 s6, v12, 2
    v_readlane_b32 s7, v12, 3
    s_mov_b32 s32, 0
    s_mov_b32 s30, s31
    v_add_lshl_u32 v5, v12, v7, 4
    ds_read_b128 v[8:11], v5 offset:0
    v_add_lshl_u32 v5, s4, v3, 2
    ds_read_b32 v6, v5 offset:41088
    s_cmp_gt_u32 s31, 0
    s_cbranch_scc0 K2_t0
    s_waitcnt lgkmcnt(0)
    v_add_u32 v6, v6, v4
    buffer_load_dwordx4 v[32:35], v6, s[8:11], 0 offen offset:0
    buffer_load_dwordx4 v[36:39], v6, s[8:11], 0 offen offset:256
    buffer_load_dwordx4 v[40:43], v6, s[8:11], 0 offen offset:512
    buffer_load_dwordx4 v[44:47], v6, s[8:11], 0 offen offset:768
    v_add_lshl_u32 v5, s5, v3, 2
    ds_read_b32 v6, v5 offset:41088
    s_cmp_gt_u32 s31, 1
    s_cbranch_scc0 K2_t0
    s_waitcnt lgkmcnt(0)
    v_add_u32 v6, v6, v4
    buffer_load_dwordx4 v[48:51], v6, s[8:11], 0 offen offset:0
    buffer_load_dwordx4 v[52:55], v6, s[8:11], 0 offen offset:256
    buffer_load_dwordx4 v[56:59], v6, s[8:11], 0 offen offset:512
    buffer_load_dwordx4 v[60:63], v6, s[8:11], 0 offen offset:768
    v_add_lshl_u32 v5, s6, v3, 2
    ds_read_b32 v6, v5 offset:41088
    s_cmp_gt_u32 s31, 2
    s_cbranch_scc0 K2_t0
    s_waitcnt lgkmcnt(0)
    v_add_u32 v6, v6, v4
    buffer_load_dwordx4 v[64:67], v6, s[8:11], 0 offen offset:0
    buffer_load_dwordx4 v[68:71], v6, s[8:11], 0 offen offset:256
    buffer_load_dwordx4 v[72:75], v6, s[8:11], 0 offen offset:512
    buffer_load_dwordx4 v[76:79], v6, s[8:11], 0 offen offset:768
    v_add_lshl_u32 v5, s7, v3, 2
    ds_read_b32 v6, v5 offset:41088
    s_branch K2_t0
K2_re0:
    s_add_u32 s32, s32, 1
    s_lshr_b32 s34, s20, 2
    s_add_u32 s34, s34, s32
    s_setprio 0
    s_bitcmp1_b32 s34, 0
    s_cbranch_scc0 K2_pr0
    s_setprio 1
K2_pr0:
    s_lshr_b64 s[24:25], s[24:25], 8
    s_and_b32 s34, s32, 3
    s_cbranch_scc0 K2_rx0
K2_t0:
    s_bitcmp1_b32 s24, 0
    s_cbranch_scc0 K2_t16
    s_sub_u32 s31, s31, 1
    s_waitcnt lgkmcnt(0)
    v_readlane_b32 s29, v2, 0
    s_cmp_lt_u32 s31, 3
    v_perm_b32 v5, v9, v8, v0
    v_lshlrev_b32 v20, 16, v10
    v_and_b32 v21, 0xffff0000, v10
    v_lshlrev_b32 v22, 16, v11
    v_and_b32 v23, 0xffff0000, v11
    v_mul_f32 v20, v20, v5
    v_mul_f32 v21, v21, v5
    v_mul_f32 v22, v22, v5
    v_mul_f32 v23, v23, v5
    v_cvt_pk_bf16_f32 v8, v20, v21
    v_cvt_pk_bf16_f32 v9, v22, v23
    v_add_u32 v6, v6, v4
    s_nop 0
    v_mfma_f32_16x16x16_bf16 v[80:83], v[8:9], v[24:25], 0
    v_mfma_f32_16x16x16_bf16 v[84:87], v[8:9], v[26:27], 0
    v_mfma_f32_16x16x16_bf16 v[88:91], v[8:9], v[28:29], 0
    v_mfma_f32_16x16x16_bf16 v[92:95], v[8:9], v[30:31], 0
    s_cbranch_scc1 K2_wx0
    s_waitcnt vmcnt(8)
K2_wr0:
    v_perm_b32 v20, v36, v32, s21
    v_perm_b32 v21, v44, v40, s21
    v_perm_b32 v22, v36, v32, s22
    v_perm_b32 v23, v44, v40, s22
    s_nop 1
    v_cvt_pk_bf16_f32 v12, v80, v84
    v_cvt_pk_bf16_f32 v14, v81, v85
    v_cvt_pk_bf16_f32 v16, v82, v86
    v_cvt_pk_bf16_f32 v18, v83, v87
    v_cvt_pk_bf16_f32 v13, v88, v92
    v_cvt_pk_bf16_f32 v15, v89, v93
    v_cvt_pk_bf16_f32 v17, v90, v94
    v_cvt_pk_bf16_f32 v19, v91, v95
    s_cbranch_scc1 K2_nl0
    buffer_load_dwordx4 v[80:83], v6, s[8:11], 0 offen offset:0
    buffer_load_dwordx4 v[84:87], v6, s[8:11], 0 offen offset:256
    buffer_load_dwordx4 v[88:91], v6, s[8:11], 0 offen offset:512
    buffer_load_dwordx4 v[92:95], v6, s[8:11], 0 offen offset:768
K2_nl0:
    v_add_lshl_u32 v5, s29, v3, 2
    ds_read_b32 v6, v5 offset:41088
    v_mfma_f32_16x16x16_bf16 v[96:99], v[12:13], v[20:21], v[96:99]
    v_perm_b32 v20, v37, v33, s21
    v_perm_b32 v21, v45, v41, s21
    v_mfma_f32_16x16x16_bf16 v[100:103], v[12:13], v[22:23], v[100:103]
    v_perm_b32 v22, v37, v33, s22
    v_perm_b32 v23, v45, v41, s22
    v_mfma_f32_16x16x16_bf16 v[104:107], v[12:13], v[20:21], v[104:107]
    v_perm_b32 v20, v38, v34, s21
    v_perm_b32 v21, v46, v42, s21
    v_mfma_f32_16x16x16_bf16 v[108:111], v[12:13], v[22:23], v[108:111]
    v_perm_b32 v22, v38, v34, s22
    v_perm_b32 v23, v46, v42, s22
    v_mfma_f32_16x16x16_bf16 v[112:115], v[12:13], v[20:21], v[112:115]
    v_perm_b32 v20, v39, v35, s21
    v_perm_b32 v21, v47, v43, s21
    v_mfma_f32_16x16x16_bf16 v[116:119], v[12:13], v[22:23], v[116:119]
    v_perm_b32 v22, v39, v35, s22
    v_perm_b32 v23, v47, v43, s22
    v_mfma_f32_16x16x16_bf16 v[120:123], v[12:13], v[20:21], v[120:123]
    s_nop 0
    v_mfma_f32_16x16x16_bf16 v[124:127], v[12:13], v[22:23], v[124:127]
K2_t1:
    s_bitcmp1_b32 s24, 1
    s_cbranch_scc0 K2_t17
    s_sub_u32 s31, s31, 1
    s_waitcnt lgkmcnt(0)
    v_readlane_b32 s29, v2, 1
    s_cmp_lt_u32 s31, 3
    v_add_u32 v6, v6, v4
    s_cbranch_scc1 K2_nl1
    buffer_load_dwordx4 v[32:35], v6, s[8:11], 0 offen offset:0
    buffer_load_dwordx4 v[36:39], v6, s[8:11], 0 offen offset:256
    buffer_load_dwordx4 v[40:43], v6, s[8:11], 0 offen offset:512
    buffer_load_dwordx4 v[44:47], v6, s[8:11], 0 offen offset:768
K2_nl1:
    v_add_lshl_u32 v5, s29, v3, 2
    ds_read_b32 v6, v5 offset:41088
    s_cbranch_scc1 K2_wx1
    s_waitcnt vmcnt(12)
K2_wr1:
    v_perm_b32 v20, v52, v48, s21
    v_perm_b32 v21, v60, v56, s21
    v_perm_b32 v22, v52, v48, s22
    v_perm_b32 v23, v60, v56, s22
    v_mfma_f32_16x16x16_bf16 v[128:131], v[14:15], v[20:21], v[128:131]
    v_perm_b32 v20, v53, v49, s21
    v_perm_b32 v21, v61, v57, s21
    v_mfma_f32_16x16x16_bf16 v[132:135], v[14:15], v[22:23], v[132:135]
    v_perm_b32 v22, v53, v49, s22
    v_perm_b32 v23, v61, v57, s22
    v_mfma_f32_16x16x16_bf16 v[136:139], v[14:15], v[20:21], v[136:139]
    v_perm_b32 v20, v54, v50, s21
    v_perm_b32 v21, v62, v58, s21
    v_mfma_f32_16x16x16_bf16 v[140:143], v[14:15], v[22:23], v[140:143]
    v_perm_b32 v22, v54, v50, s22
    v_perm_b32 v23, v62, v58, s22
    v_mfma_f32_16x16x16_bf16 v[144:147], v[14:15], v[20:21], v[144:147]
    v_perm_b32 v20, v55, v51, s21
    v_perm_b32 v21, v63, v59, s21
    v_mfma_f32_16x16x16_bf16 v[148:151], v[14:15], v[22:23], v[148:151]
    v_perm_b32 v22, v55, v51, s22
    v_perm_b32 v23, v63, v59, s22
    v_mfma_f32_16x16x16_bf16 v[152:155], v[14:15], v[20:21], v[152:155]
    s_nop 0
    v_mfma_f32_16x16x16_bf16 v[156:159], v[14:15], v[22:23], v[156:159]
K2_t2:
    s_bitcmp1_b32 s24, 2
    s_cbranch_scc0 K2_t18
    s_sub_u32 s31, s31, 1
    s_waitcnt lgkmcnt(0)
    v_readlane_b32 s29, v2, 2
    s_cmp_lt_u32 s31, 3
    v_add_u32 v6, v6, v4
    s_cbranch_scc1 K2_nl2
    buffer_load_dwordx4 v[48:51], v6, s[8:11], 0 offen offset:0
    buffer_load_dwordx4 v[52:55], v6, s[8:11], 0 offen offset:256
    buffer_load_dwordx4 v[56:59], v6, s[8:11], 0 offen offset:512
    buffer_load_dwordx4 v[60:63], v6, s[8:11], 0 offen offset:768
K2_nl2:
    v_add_lshl_u32 v5, s29, v3, 2
    ds_read_b32 v6, v5 offset:41088
    v_add_lshl_u32 v5, v2, v7, 4
    ds_read_b128 v[8:11], v5 offset:0
    s_cbranch_scc1 K2_wx2
    s_waitcnt vmcnt(12)
K2_wr2:
    v_perm_b32 v20, v68, v64, s21
    v_perm_b32 v21, v76, v72, s21
    v_perm_b32 v22, v68, v64, s22
    v_perm_b32 v23, v76, v72, s22
    v_mfma_f32_16x16x16_bf16 v[160:163], v[16:17], v[20:21], v[160:163]
    v_perm_b32 v20, v69, v65, s21
    v_perm_b32 v21, v77, v73, s21
    v_mfma_f32_16x16x16_bf16 v[164:167], v[16:17], v[22:23], v[164:167]
    v_perm_b32 v22, v69, v65, s22
    v_perm_b32 v23, v77, v73, s22
    v_mfma_f32_16x16x16_bf16 v[168:171], v[16:17], v[20:21], v[168:171]
    v_perm_b32 v20, v70, v66, s21
    v_perm_b32 v21, v78, v74, s21
    v_mfma_f32_16x16x16_bf16 v[172:175], v[16:17], v[22:23], v[172:175]
    v_perm_b32 v22, v70, v66, s22
    v_perm_b32 v23, v78, v74, s22
    v_mfma_f32_16x16x16_bf16 v[176:179], v[16:17], v[20:21], v[176:179]
    v_perm_b32 v20, v71, v67, s21
    v_perm_b32 v21, v79, v75, s21
    v_mfma_f32_16x16x16_bf16 v[180:183], v[16:17], v[22:23], v[180:183]
    v_perm_b32 v22, v71, v67, s22
    v_perm_b32 v23, v79, v75, s22
    v_mfma_f32_16x16x16_bf16 v[184:187], v[16:17], v[20:21], v[184:187]
    s_nop 0
    v_mfma_f32_16x16x16_bf16 v[188:191], v[16:17], v[22:23], v[188:191]
K2_t3:
    s_bitcmp1_b32 s24, 3
    s_cbranch_scc0 K2_t19
    s_sub_u32 s31, s31, 1
    s_waitcnt lgkmcnt(0)
    v_readlane_b32 s29, v2, 3
    s_cmp_lt_u32 s31, 3
    v_add_u32 v6, v6, v4
    s_cbranch_scc1 K2_nl3
    buffer_load_dwordx4 v[64:67], v6, s[8:11], 0 offen offset:0
    buffer_load_dwordx4 v[68:71], v6, s[8:11], 0 offen offset:256
    buffer_load_dwordx4 v[72:75], v6, s[8:11], 0 offen offset:512
    buffer_load_dwordx4 v[76:79], v6, s[8:11], 0 offen offset:768
K2_nl3:
    v_add_lshl_u32 v5, s29, v3, 2
    ds_read_b32 v6, v5 offset:41088
    v_add_u32 v1, 16, v1
    ds_read_b32 v2, v1 offset:54720
    s_cbranch_scc1 K2_wx3
    s_waitcnt vmcnt(12)
K2_wr3:
    v_perm_b32 v20, v84, v80, s21
    v_perm_b32 v21, v92, v88, s21
    v_perm_b32 v22, v84, v80, s22
    v_perm_b32 v23, v92, v88, s22
    v_mfma_f32_16x16x16_bf16 v[192:195], v[18:19], v[20:21], v[192:195]
    v_perm_b32 v20, v85, v81, s21
    v_perm_b32 v21, v93, v89, s21
    v_mfma_f32_16x16x16_bf16 v[196:199], v[18:19], v[22:23], v[196:199]
    v_perm_b32 v22, v85, v81, s22
    v_perm_b32 v23, v93, v89, s22
    v_mfma_f32_16x16x16_bf16 v[200:203], v[18:19], v[20:21], v[200:203]
    v_perm_b32 v20, v86, v82, s21
    v_perm_b32 v21, v94, v90, s21
    v_mfma_f32_16x16x16_bf16 v[204:207], v[18:19], v[22:23], v[204:207]
    v_perm_b32 v22, v86, v82, s22
    v_perm_b32 v23, v94, v90, s22
    v_mfma_f32_16x16x16_bf16 v[208:211], v[18:19], v[20:21], v[208:211]
    v_perm_b32 v20, v87, v83, s21
    v_perm_b32 v21, v95, v91, s21
    v_mfma_f32_16x16x16_bf16 v[212:215], v[18:19], v[22:23], v[212:215]
    v_perm_b32 v22, v87, v83, s22
    v_perm_b32 v23, v95, v91, s22
    v_mfma_f32_16x16x16_bf16 v[216:219], v[18:19], v[20:21], v[216:219]
    s_nop 0
    v_mfma_f32_16x16x16_bf16 v[220:223], v[18:19], v[22:23], v[220:223]
K2_t4:
    s_bitcmp1_b32 s24, 4
    s_cbranch_scc0 K2_re0
    s_sub_u32 s31, s31, 1
    s_waitcnt lgkmcnt(0)
    v_readlane_b32 s29, v2, 0
    s_cmp_lt_u32 s31, 3
    v_perm_b32 v5, v9, v8, v0
    v_lshlrev_b32 v20, 16, v10
    v_and_b32 v21, 0xffff0000, v10
    v_lshlrev_b32 v22, 16, v11
    v_and_b32 v23, 0xffff0000, v11
    v_mul_f32 v20, v20, v5
    v_mul_f32 v21, v21, v5
    v_mul_f32 v22, v22, v5
    v_mul_f32 v23, v23, v5
    v_cvt_pk_bf16_f32 v8, v20, v21
    v_cvt_pk_bf16_f32 v9, v22, v23
    v_add_u32 v6, v6, v4
    s_nop 0
    v_mfma_f32_16x16x16_bf16 v[80:83], v[8:9], v[24:25], 0
    v_mfma_f32_16x16x16_bf16 v[84:87], v[8:9], v[26:27], 0
    v_mfma_f32_16x16x16_bf16 v[88:91], v[8:9], v[28:29], 0
    v_mfma_f32_16x16x16_bf16 v[92:95], v[8:9], v[30:31], 0
    s_cbranch_scc1 K2_wx4
    s_waitcnt vmcnt(8)
K2_wr4:
    v_perm_b32 v20, v36, v32, s21
    v_perm_b32 v21, v44, v40, s21
    v_perm_b32 v22, v36, v32, s22
    v_perm_b32 v23, v44, v40, s22
    s_nop 1
    v_cvt_pk_bf16_f32 v12, v80, v84
    v_cvt_pk_bf16_f32 v14, v81, v85
    v_cvt_pk_bf16_f32 v16, v82, v86
    v_cvt_pk_bf16_f32 v18, v83, v87
    v_cvt_pk_bf16_f32 v13, v88, v92
    v_cvt_pk_bf16_f32 v15, v89, v93
    v_cvt_pk_bf16_f32 v17, v90, v94
    v_cvt_pk_bf16_f32 v19, v91, v95
    s_cbranch_scc1 K2_nl4
    buffer_load_dwordx4 v[80:83], v6, s[8:11], 0 offen offset:0
    buffer_load_dwordx4 v[84:87], v6, s[8:11], 0 offen offset:256
    buffer_load_dwordx4 v[88:91], v6, s[8:11], 0 offen offset:512
    buffer_load_dwordx4 v[92:95], v6, s[8:11], 0 offen offset:768
K2_nl4:
    v_add_lshl_u32 v5, s29, v3, 2
    ds_read_b32 v6, v5 offset:41088
    v_mfma_f32_16x16x16_bf16 v[224:227], v[12:13], v[20:21], v[224:227]
    v_perm_b32 v20, v37, v33, s21
    v_perm_b32 v21, v45, v41, s21
    v_mfma_f32_16x16x16_bf16 v[228:231], v[12:13], v[22:23], v[228:231]
    v_perm_b32 v22, v37, v33, s22
    v_perm_b32 v23, v45, v41, s22
    v_mfma_f32_16x16x16_bf16 v[232:235], v[12:13], v[20:21], v[232:235]
    v_perm_b32 v20, v38, v34, s21
    v_perm_b32 v21, v46, v42, s21
    v_mfma_f32_16x16x16_bf16 v[236:239], v[12:13], v[22:23], v[236:239]
    v_perm_b32 v22, v38, v34, s22
    v_perm_b32 v23, v46, v42, s22
    v_mfma_f32_16x16x16_bf16 v[240:243], v[12:13], v[20:21], v[240:243]
    v_perm_b32 v20, v39, v35, s21
    v_perm_b32 v21, v47, v43, s21
    v_mfma_f32_16x16x16_bf16 v[244:247], v[12:13], v[22:23], v[244:247]
    v_perm_b32 v22, v39, v35, s22
    v_perm_b32 v23, v47, v43, s22
    v_mfma_f32_16x16x16_bf16 v[248:251], v[12:13], v[20:21], v[248:251]
    s_nop 0
    v_mfma_f32_16x16x16_bf16 v[252:255], v[12:13], v[22:23], v[252:255]
K2_re5:
    s_add_u32 s32, s32, 1
    s_lshr_b32 s34, s20, 2
    s_add_u32 s34, s34, s32
    s_setprio 0
    s_bitcmp1_b32 s34, 0
    s_cbranch_scc0 K2_pr5
    s_setprio 1
K2_pr5:
    s_lshr_b64 s[24:25], s[24:25], 8
    s_and_b32 s34, s32, 3
    s_cbranch_scc0 K2_rx5
K2_t5:
    s_bitcmp1_b32 s24, 0
    s_cbranch_scc0 K2_t1
    s_sub_u32 s31, s31, 1
    s_waitcnt lgkmcnt(0)
    v_readlane_b32 s29, v2, 1
    s_cmp_lt_u32 s31, 3
    v_add_u32 v6, v6, v4
    s_cbranch_scc1 K2_nl5
    buffer_load_dwordx4 v[32:35], v6, s[8:11], 0 offen offset:0
    buffer_load_dwordx4 v[36:39], v6, s[8:11], 0 offen offset:256
    buffer_load_dwordx4 v[40:43], v6, s[8:11], 0 offen offset:512
    buffer_load_dwordx4 v[44:47], v6, s[8:11], 0 offen offset:768
K2_nl5:
    v_add_lshl_u32 v5, s29, v3, 2
    ds_read_b32 v6, v5 offset:41088
    s_cbranch_scc1 K2_wx5
    s_waitcnt vmcnt(12)
K2_wr5:
    v_perm_b32 v20, v52, v48, s21
    v_perm_b32 v21, v60, v56, s21
    v_perm_b32 v22, v52, v48, s22
    v_perm_b32 v23, v60, v56, s22
    v_mfma_f32_16x16x16_bf16 v[96:99], v[14:15], v[20:21], v[96:99]
    v_perm_b32 v20, v53, v49, s21
    v_perm_b32 v21, v61, v57, s21
    v_mfma_f32_16x16x16_bf16 v[100:103], v[14:15], v[22:23], v[100:103]
    v_perm_b32 v22, v53, v49, s22
    v_perm_b32 v23, v61, v57, s22
    v_mfma_f32_16x16x16_bf16 v[104:107], v[14:15], v[20:21], v[104:107]
    v_perm_b32 v20, v54, v50, s21
    v_perm_b32 v21, v62, v58, s21
    v_mfma_f32_16x16x16_bf16 v[108:111], v[14:15], v[22:23], v[108:111]
    v_perm_b32 v22, v54, v50, s22
    v_perm_b32 v23, v62, v58, s22
    v_mfma_f32_16x16x16_bf16 v[112:115], v[14:15], v[20:21], v[112:115]
    v_perm_b32 v20, v55, v51, s21
    v_perm_b32 v21, v63, v59, s21
    v_mfma_f32_16x16x16_bf16 v[116:119], v[14:15], v[22:23], v[116:119]
    v_perm_b32 v22, v55, v51, s22
    v_perm_b32 v23, v63, v59, s22
    v_mfma_f32_16x16x16_bf16 v[120:123], v[14:15], v[20:21], v[120:123]
    s_nop 0
    v_mfma_f32_16x16x16_bf16 v[124:127], v[14:15], v[22:23], v[124:127]
K2_t6:
    s_bitcmp1_b32 s24, 1
    s_cbranch_scc0 K2_t2
    s_sub_u32 s31, s31, 1
    s_waitcnt lgkmcnt(0)
    v_readlane_b32 s29, v2, 2
    s_cmp_lt_u32 s31, 3
    v_add_u32 v6, v6, v4
    s_cbranch_scc1 K2_nl6
    buffer_load_dwordx4 v[48:51], v6, s[8:11], 0 offen offset:0
    buffer_load_dwordx4 v[52:55], v6, s[8:11], 0 offen offset:256
    buffer_load_dwordx4 v[56:59], v6, s[8:11], 0 offen offset:512
    buffer_load_dwordx4 v[60:63], v6, s[8:11], 0 offen offset:768
K2_nl6:
    v_add_lshl_u32 v5, s29, v3, 2
    ds_read_b32 v6, v5 offset:41088
    v_add_lshl_u32 v5, v2, v7, 4
    ds_read_b128 v[8:11], v5 offset:0
    s_cbranch_scc1 K2_wx6
    s_waitcnt vmcnt(12)
K2_wr6:
    v_perm_b32 v20, v68, v64, s21
    v_perm_b32 v21, v76, v72, s21
    v_perm_b32 v22, v68, v64, s22
    v_perm_b32 v23, v76, v72, s22
    v_mfma_f32_16x16x16_bf16 v[128:131], v[16:17], v[20:21], v[128:131]
    v_perm_b32 v20, v69, v65, s21
    v_perm_b32 v21, v77, v73, s21
    v_mfma_f32_16x16x16_bf16 v[132:135], v[16:17], v[22:23], v[132:135]
    v_perm_b32 v22, v69, v65, s22
    v_perm_b32 v23, v77, v73, s22
    v_mfma_f32_16x16x16_bf16 v[136:139], v[16:17], v[20:21], v[136:139]
    v_perm_b32 v20, v70, v66, s21
    v_perm_b32 v21, v78, v74, s21
    v_mfma_f32_16x16x16_bf16 v[140:143], v[16:17], v[22:23], v[140:143]
    v_perm_b32 v22, v70, v66, s22
    v_perm_b32 v23, v78, v74, s22
    v_mfma_f32_16x16x16_bf16 v[144:147], v[16:17], v[20:21], v[144:147]
    v_perm_b32 v20, v71, v67, s21
    v_perm_b32 v21, v79, v75, s21
    v_mfma_f32_16x16x16_bf16 v[148:151], v[16:17], v[22:23], v[148:151]
    v_perm_b32 v22, v71, v67, s22
    v_perm_b32 v23, v79, v75, s22
    v_mfma_f32_16x16x16_bf16 v[152:155], v[16:17], v[20:21], v[152:155]
    s_nop 0
    v_mfma_f32_16x16x16_bf16 v[156:159], v[16:17], v[22:23], v[156:159]
K2_t7:
    s_bitcmp1_b32 s24, 2
    s_cbranch_scc0 K2_t3
    s_sub_u32 s31, s31, 1
    s_waitcnt lgkmcnt(0)
    v_readlane_b32 s29, v2, 3
    s_cmp_lt_u32 s31, 3
    v_add_u32 v6, v6, v4
    s_cbranch_scc1 K2_nl7
    buffer_load_dwordx4 v[64:67], v6, s[8:11], 0 offen offset:0
    buffer_load_dwordx4 v[68:71], v6, s[8:11], 0 offen offset:256
    buffer_load_dwordx4 v[72:75], v6, s[8:11], 0 offen offset:512
    buffer_load_dwordx4 v[76:79], v6, s[8:11], 0 offen offset:768
K2_nl7:
    v_add_lshl_u32 v5, s29, v3, 2
    ds_read_b32 v6, v5 offset:41088
    v_add_u32 v1, 16, v1
    ds_read_b32 v2, v1 offset:54720
    s_cbranch_scc1 K2_wx7
    s_waitcnt vmcnt(12)
K2_wr7:
    v_perm_b32 v20, v84, v80, s21
    v_perm_b32 v21, v92, v88, s21
    v_perm_b32 v22, v84, v80, s22
    v_perm_b32 v23, v92, v88, s22
    v_mfma_f32_16x16x16_bf16 v[160:163], v[18:19], v[20:21], v[160:163]
    v_perm_b32 v20, v85, v81, s21
    v_perm_b32 v21, v93, v89, s21
    v_mfma_f32_16x16x16_bf16 v[164:167], v[18:19], v[22:23], v[164:167]
    v_perm_b32 v22, v85, v81, s22
    v_perm_b32 v23, v93, v89, s22
    v_mfma_f32_16x16x16_bf16 v[168:171], v[18:19], v[20:21], v[168:171]
    v_perm_b32 v20, v86, v82, s21
    v_perm_b32 v21, v94, v90, s21
    v_mfma_f32_16x16x16_bf16 v[172:175], v[18:19], v[22:23], v[172:175]
    v_perm_b32 v22, v86, v82, s22
    v_perm_b32 v23, v94, v90, s22
    v_mfma_f32_16x16x16_bf16 v[176:179], v[18:19], v[20:21], v[176:179]
    v_perm_b32 v20, v87, v83, s21
    v_perm_b32 v21, v95, v91, s21
    v_mfma_f32_16x16x16_bf16 v[180:183], v[18:19], v[22:23], v[180:183]
    v_perm_b32 v22, v87, v83, s22
    v_perm_b32 v23, v95, v91, s22
    v_mfma_f32_16x16x16_bf16 v[184:187], v[18:19], v[20:21], v[184:187]
    s_nop 0
    v_mfma_f32_16x16x16_bf16 v[188:191], v[18:19], v[22:23], v[188:191]
K2_t8:
    s_bitcmp1_b32 s24, 3
    s_cbranch_scc0 K2_t4
    s_sub_u32 s31, s31, 1
    s_waitcnt lgkmcnt(0)
    v_readlane_b32 s29, v2, 0
    s_cmp_lt_u32 s31, 3
    v_perm_b32 v5, v9, v8, v0
    v_lshlrev_b32 v20, 16, v10
    v_and_b32 v21, 0xffff0000, v10
    v_lshlrev_b32 v22, 16, v11
    v_and_b32 v23, 0xffff0000, v11
    v_mul_f32 v20, v20, v5
    v_mul_f32 v21, v21, v5
    v_mul_f32 v22, v22, v5
    v_mul_f32 v23, v23, v5
    v_cvt_pk_bf16_f32 v8, v20, v21
    v_cvt_pk_bf16_f32 v9, v22, v23
    v_add_u32 v6, v6, v4
    s_nop 0
    v_mfma_f32_16x16x16_bf16 v[80:83], v[8:9], v[24:25], 0
    v_mfma_f32_16x16x16_bf16 v[84:87], v[8:9], v[26:27], 0
    v_mfma_f32_16x16x16_bf16 v[88:91], v[8:9], v[28:29], 0
    v_mfma_f32_16x16x16_bf16 v[92:95], v[8:9], v[30:31], 0
    s_cbranch_scc1 K2_wx8
    s_waitcnt vmcnt(8)
K2_wr8:
    v_perm_b32 v20, v36, v32, s21
    v_perm_b32 v21, v44, v40, s21
    v_perm_b32 v22, v36, v32, s22
    v_perm_b32 v23, v44, v40, s22
    s_nop 1
    v_cvt_pk_bf16_f32 v12, v80, v84
    v_cvt_pk_bf16_f32 v14, v81, v85
    v_cvt_pk_bf16_f32 v16, v82, v86
    v_cvt_pk_bf16_f32 v18, v83, v87
    v_cvt_pk_bf16_f32 v13, v88, v92
    v_cvt_pk_bf16_f32 v15, v89, v93
    v_cvt_pk_bf16_f32 v17, v90, v94
    v_cvt_pk_bf16_f32 v19, v91, v95
    s_cbranch_scc1 K2_nl8
    buffer_load_dwordx4 v[80:83], v6, s[8:11], 0 offen offset:0
    buffer_load_dwordx4 v[84:87], v6, s[8:11], 0 offen offset:256
    buffer_load_dwordx4 v[88:91], v6, s[8:11], 0 offen offset:512
    buffer_load_dwordx4 v[92:95], v6, s[8:11], 0 offen offset:768
K2_nl8:
    v_add_lshl_u32 v5, s29, v3, 2
    ds_read_b32 v6, v5 offset:41088
    v_mfma_f32_16x16x16_bf16 v[192:195], v[12:13], v[20:21], v[192:195]
    v_perm_b32 v20, v37, v33, s21
    v_perm_b32 v21, v45, v41, s21
    v_mfma_f32_16x16x16_bf16 v[196:199], v[12:13], v[22:23], v[196:199]
    v_perm_b32 v22, v37, v33, s22
    v_perm_b32 v23, v45, v41, s22
    v_mfma_f32_16x16x16_bf16 v[200:203], v[12:13], v[20:21], v[200:203]
    v_perm_b32 v20, v38, v34, s21
    v_perm_b32 v21, v46, v42, s21
    v_mfma_f32_16x16x16_bf16 v[204:207], v[12:13], v[22:23], v[204:207]
    v_perm_b32 v22, v38, v34, s22
    v_perm_b32 v23, v46, v42, s22
    v_mfma_f32_16x16x16_bf16 v[208:211], v[12:13], v[20:21], v[208:211]
    v_perm_b32 v20, v39, v35, s21
    v_perm_b32 v21, v47, v43, s21
    v_mfma_f32_16x16x16_bf16 v[212:215], v[12:13], v[22:23], v[212:215]
    v_perm_b32 v22, v39, v35, s22
    v_perm_b32 v23, v47, v43, s22
    v_mfma_f32_16x16x16_bf16 v[216:219], v[12:13], v[20:21], v[216:219]
    s_nop 0
    v_mfma_f32_16x16x16_bf16 v[220:223], v[12:13], v[22:23], v[220:223]
K2_t9:
    s_bitcmp1_b32 s24, 4
    s_cbranch_scc0 K2_re5
    s_sub_u32 s31, s31, 1
    s_waitcnt lgkmcnt(0)
    v_readlane_b32 s29, v2, 1
    s_cmp_lt_u32 s31, 3
    v_add_u32 v6, v6, v4
    s_cbranch_scc1 K2_nl9
    buffer_load_dwordx4 v[32:35], v6, s[8:11], 0 offen offset:0
    buffer_load_dwordx4 v[36:39], v6, s[8:11], 0 offen offset:256
    buffer_load_dwordx4 v[40:43], v6, s[8:11], 0 offen offset:512
    buffer_load_dwordx4 v[44:47], v6, s[8:11], 0 offen offset:768
K2_nl9:
    v_add_lshl_u32 v5, s29, v3, 2
    ds_read_b32 v6, v5 offset:41088
    s_cbranch_scc1 K2_wx9
    s_waitcnt vmcnt(12)
K2_wr9:
    v_perm_b32 v20, v52, v48, s21
    v_perm_b32 v21, v60, v56, s21
    v_perm_b32 v22, v52, v48, s22
    v_perm_b32 v23, v60, v56, s22
    v_mfma_f32_16x16x16_bf16 v[224:227], v[14:15], v[20:21], v[224:227]
    v_perm_b32 v20, v53, v49, s21
    v_perm_b32 v21, v61, v57, s21
    v_mfma_f32_16x16x16_bf16 v[228:231], v[14:15], v[22:23], v[228:231]
    v_perm_b32 v22, v53, v49, s22
    v_perm_b32 v23, v61, v57, s22
    v_mfma_f32_16x16x16_bf16 v[232:235], v[14:15], v[20:21], v[232:235]
    v_perm_b32 v20, v54, v50, s21
    v_perm_b32 v21, v62, v58, s21
    v_mfma_f32_16x16x16_bf16 v[236:239], v[14:15], v[22:23], v[236:239]
    v_perm_b32 v22, v54, v50, s22
    v_perm_b32 v23, v62, v58, s22
    v_mfma_f32_16x16x16_bf16 v[240:243], v[14:15], v[20:21], v[240:243]
    v_perm_b32 v20, v55, v51, s21
    v_perm_b32 v21, v63, v59, s21
    v_mfma_f32_16x16x16_bf16 v[244:247], v[14:15], v[22:23], v[244:247]
    v_perm_b32 v22, v55, v51, s22
    v_perm_b32 v23, v63, v59, s22
    v_mfma_f32_16x16x16_bf16 v[248:251], v[14:15], v[20:21], v[248:251]
    s_nop 0
    v_mfma_f32_16x16x16_bf16 v[252:255], v[14:15], v[22:23], v[252:255]
K2_re10:
    s_add_u32 s32, s32, 1
    s_lshr_b32 s34, s20, 2
    s_add_u32 s34, s34, s32
    s_setprio 0
    s_bitcmp1_b32 s34, 0
    s_cbranch_scc0 K2_pr10
    s_setprio 1
K2_pr10:
    s_lshr_b64 s[24:25], s[24:25], 8
    s_and_b32 s34, s32, 3
    s_cbranch_scc0 K2_rx10
K2_t10:
    s_bitcmp1_b32 s24, 0
    s_cbranch_scc0 K2_t6
    s_sub_u32 s31, s31, 1
    s_waitcnt lgkmcnt(0)
    v_readlane_b32 s29, v2, 2
    s_cmp_lt_u32 s31, 3
    v_add_u32 v6, v6, v4
    s_cbranch_scc1 K2_nl10
    buffer_load_dwordx4 v[48:51], v6, s[8:11], 0 offen offset:0
    buffer_load_dwordx4 v[52:55], v6, s[8:11], 0 offen offset:256
    buffer_load_dwordx4 v[56:59], v6, s[8:11], 0 offen offset:512
    buffer_load_dwordx4 v[60:63], v6, s[8:11], 0 offen offset:768
K2_nl10:
    v_add_lshl_u32 v5, s29, v3, 2
    ds_read_b32 v6, v5 offset:41088
    v_add_lshl_u32 v5, v2, v7, 4
    ds_read_b128 v[8:11], v5 offset:0
    s_cbranch_scc1 K2_wx10
    s_waitcnt vmcnt(12)
K2_wr10:
    v_perm_b32 v20, v68, v64, s21
    v_perm_b32 v21, v76, v72, s21
    v_perm_b32 v22, v68, v64, s22
    v_perm_b32 v23, v76, v72, s22
    v_mfma_f32_16x16x16_bf16 v[96:99], v[16:17], v[20:21], v[96:99]
    v_perm_b32 v20, v69, v65, s21
    v_perm_b32 v21, v77, v73, s21
    v_mfma_f32_16x16x16_bf16 v[100:103], v[16:17], v[22:23], v[100:103]
    v_perm_b32 v22, v69, v65, s22
    v_perm_b32 v23, v77, v73, s22
    v_mfma_f32_16x16x16_bf16 v[104:107], v[16:17], v[20:21], v[104:107]
    v_perm_b32 v20, v70, v66, s21
    v_perm_b32 v21, v78, v74, s21
    v_mfma_f32_16x16x16_bf16 v[108:111], v[16:17], v[22:23], v[108:111]
    v_perm_b32 v22, v70, v66, s22
    v_perm_b32 v23, v78, v74, s22
    v_mfma_f32_16x16x16_bf16 v[112:115], v[16:17], v[20:21], v[112:115]
    v_perm_b32 v20, v71, v67, s21
    v_perm_b32 v21, v79, v75, s21
    v_mfma_f32_16x16x16_bf16 v[116:119], v[16:17], v[22:23], v[116:119]
    v_perm_b32 v22, v71, v67, s22
    v_perm_b32 v23, v79, v75, s22
    v_mfma_f32_16x16x16_bf16 v[120:123], v[16:17], v[20:21], v[120:123]
    s_nop 0
    v_mfma_f32_16x16x16_bf16 v[124:127], v[16:17], v[22:23], v[124:127]
K2_t11:
    s_bitcmp1_b32 s24, 1
    s_cbranch_scc0 K2_t7
    s_sub_u32 s31, s31, 1
    s_waitcnt lgkmcnt(0)
    v_readlane_b32 s29, v2, 3
    s_cmp_lt_u32 s31, 3
    v_add_u32 v6, v6, v4
    s_cbranch_scc1 K2_nl11
    buffer_load_dwordx4 v[64:67], v6, s[8:11], 0 offen offset:0
    buffer_load_dwordx4 v[68:71], v6, s[8:11], 0 offen offset:256
    buffer_load_dwordx4 v[72:75], v6, s[8:11], 0 offen offset:512
    buffer_load_dwordx4 v[76:79], v6, s[8:11], 0 offen offset:768
K2_nl11:
    v_add_lshl_u32 v5, s29, v3, 2
    ds_read_b32 v6, v5 offset:41088
    v_add_u32 v1, 16, v1
    ds_read_b32 v2, v1 offset:54720
    s_cbranch_scc1 K2_wx11
    s_waitcnt vmcnt(12)
K2_wr11:
    v_perm_b32 v20, v84, v80, s21
    v_perm_b32 v21, v92, v88, s21
    v_perm_b32 v22, v84, v80, s22
    v_perm_b32 v23, v92, v88, s22
    v_mfma_f32_16x16x16_bf16 v[128:131], v[18:19], v[20:21], v[128:131]
    v_perm_b32 v20, v85, v81, s21
    v_perm_b32 v21, v93, v89, s21
    v_mfma_f32_16x16x16_bf16 v[132:135], v[18:19], v[22:23], v[132:135]
    v_perm_b32 v22, v85, v81, s22
    v_perm_b32 v23, v93, v89, s22
    v_mfma_f32_16x16x16_bf16 v[136:139], v[18:19], v[20:21], v[136:139]
    v_perm_b32 v20, v86, v82, s21
    v_perm_b32 v21, v94, v90, s21
    v_mfma_f32_16x16x16_bf16 v[140:143], v[18:19], v[22:23], v[140:143]
    v_perm_b32 v22, v86, v82, s22
    v_perm_b32 v23, v94, v90, s22
    v_mfma_f32_16x16x16_bf16 v[144:147], v[18:19], v[20:21], v[144:147]
    v_perm_b32 v20, v87, v83, s21
    v_perm_b32 v21, v95, v91, s21
    v_mfma_f32_16x16x16_bf16 v[148:151], v[18:19], v[22:23], v[148:151]
    v_perm_b32 v22, v87, v83, s22
    v_perm_b32 v23, v95, v91, s22
    v_mfma_f32_16x16x16_bf16 v[152:155], v[18:19], v[20:21], v[152:155]
    s_nop 0
    v_mfma_f32_16x16x16_bf16 v[156:159], v[18:19], v[22:23], v[156:159]
K2_t12:
    s_bitcmp1_b32 s24, 2
    s_cbranch_scc0 K2_t8
    s_sub_u32 s31, s31, 1
    s_waitcnt lgkmcnt(0)
    v_readlane_b32 s29, v2, 0
    s_cmp_lt_u32 s31, 3
    v_perm_b32 v5, v9, v8, v0
    v_lshlrev_b32 v20, 16, v10
    v_and_b32 v21, 0xffff0000, v10
    v_lshlrev_b32 v22, 16, v11
    v_and_b32 v23, 0xffff0000, v11
    v_mul_f32 v20, v20, v5
    v_mul_f32 v21, v21, v5
    v_mul_f32 v22, v22, v5
    v_mul_f32 v23, v23, v5
    v_cvt_pk_bf16_f32 v8, v20, v21
    v_cvt_pk_bf16_f32 v9, v22, v23
    v_add_u32 v6, v6, v4
    s_nop 0
    v_mfma_f32_16x16x16_bf16 v[80:83], v[8:9], v[24:25], 0
    v_mfma_f32_16x16x16_bf16 v[84:87], v[8:9], v[26:27], 0
    v_mfma_f32_16x16x16_bf16 v[88:91], v[8:9], v[28:29], 0
    v_mfma_f32_16x16x16_bf16 v[92:95], v[8:9], v[30:31], 0
    s_cbranch_scc1 K2_wx12
    s_waitcnt vmcnt(8)
K2_wr12:
    v_perm_b32 v20, v36, v32, s21
    v_perm_b32 v21, v44, v40, s21
    v_perm_b32 v22, v36, v32, s22
    v_perm_b32 v23, v44, v40, s22
    s_nop 1
    v_cvt_pk_bf16_f32 v12, v80, v84
    v_cvt_pk_bf16_f32 v14, v81, v85
    v_cvt_pk_bf16_f32 v16, v82, v86
    v_cvt_pk_bf16_f32 v18, v83, v87
    v_cvt_pk_bf16_f32 v13, v88, v92
    v_cvt_pk_bf16_f32 v15, v89, v93
    v_cvt_pk_bf16_f32 v17, v90, v94
    v_cvt_pk_bf16_f32 v19, v91, v95
    s_cbranch_scc1 K2_nl12
    buffer_load_dwordx4 v[80:83], v6, s[8:11], 0 offen offset:0
    buffer_load_dwordx4 v[84:87], v6, s[8:11], 0 offen offset:256
    buffer_load_dwordx4 v[88:91], v6, s[8:11], 0 offen offset:512
    buffer_load_dwordx4 v[92:95], v6, s[8:11], 0 offen offset:768
K2_nl12:
    v_add_lshl_u32 v5, s29, v3, 2
    ds_read_b32 v6, v5 offset:41088
    v_mfma_f32_16x16x16_bf16 v[160:163], v[12:13], v[20:21], v[160:163]
    v_perm_b32 v20, v37, v33, s21
    v_perm_b32 v21, v45, v41, s21
    v_mfma_f32_16x16x16_bf16 v[164:167], v[12:13], v[22:23], v[164:167]
    v_perm_b32 v22, v37, v33, s22
    v_perm_b32 v23, v45, v41, s22
    v_mfma_f32_16x16x16_bf16 v[168:171], v[12:13], v[20:21], v[168:171]
    v_perm_b32 v20, v38, v34, s21
    v_perm_b32 v21, v46, v42, s21
    v_mfma_f32_16x16x16_bf16 v[172:175], v[12:13], v[22:23], v[172:175]
    v_perm_b32 v22, v38, v34, s22
    v_perm_b32 v23, v46, v42, s22
    v_mfma_f32_16x16x16_bf16 v[176:179], v[12:13], v[20:21], v[176:179]
    v_perm_b32 v20, v39, v35, s21
    v_perm_b32 v21, v47, v43, s21
    v_mfma_f32_16x16x16_bf16 v[180:183], v[12:13], v[22:23], v[180:183]
    v_perm_b32 v22, v39, v35, s22
    v_perm_b32 v23, v47, v43, s22
    v_mfma_f32_16x16x16_bf16 v[184:187], v[12:13], v[20:21], v[184:187]
    s_nop 0
    v_mfma_f32_16x16x16_bf16 v[188:191], v[12:13], v[22:23], v[188:191]
K2_t13:
    s_bitcmp1_b32 s24, 3
    s_cbranch_scc0 K2_t9
    s_sub_u32 s31, s31, 1
    s_waitcnt lgkmcnt(0)
    v_readlane_b32 s29, v2, 1
    s_cmp_lt_u32 s31, 3
    v_add_u32 v6, v6, v4
    s_cbranch_scc1 K2_nl13
    buffer_load_dwordx4 v[32:35], v6, s[8:11], 0 offen offset:0
    buffer_load_dwordx4 v[36:39], v6, s[8:11], 0 offen offset:256
    buffer_load_dwordx4 v[40:43], v6, s[8:11], 0 offen offset:512
    buffer_load_dwordx4 v[44:47], v6, s[8:11], 0 offen offset:768
K2_nl13:
    v_add_lshl_u32 v5, s29, v3, 2
    ds_read_b32 v6, v5 offset:41088
    s_cbranch_scc1 K2_wx13
    s_waitcnt vmcnt(12)
K2_wr13:
    v_perm_b32 v20, v52, v48, s21
    v_perm_b32 v21, v60, v56, s21
    v_perm_b32 v22, v52, v48, s22
    v_perm_b32 v23, v60, v56, s22
    v_mfma_f32_16x16x16_bf16 v[192:195], v[14:15], v[20:21], v[192:195]
    v_perm_b32 v20, v53, v49, s21
    v_perm_b32 v21, v61, v57, s21
    v_mfma_f32_16x16x16_bf16 v[196:199], v[14:15], v[22:23], v[196:199]
    v_perm_b32 v22, v53, v49, s22
    v_perm_b32 v23, v61, v57, s22
    v_mfma_f32_16x16x16_bf16 v[200:203], v[14:15], v[20:21], v[200:203]
    v_perm_b32 v20, v54, v50, s21
    v_perm_b32 v21, v62, v58, s21
    v_mfma_f32_16x16x16_bf16 v[204:207], v[14:15], v[22:23], v[204:207]
    v_perm_b32 v22, v54, v50, s22
    v_perm_b32 v23, v62, v58, s22
    v_mfma_f32_16x16x16_bf16 v[208:211], v[14:15], v[20:21], v[208:211]
    v_perm_b32 v20, v55, v51, s21
    v_perm_b32 v21, v63, v59, s21
    v_mfma_f32_16x16x16_bf16 v[212:215], v[14:15], v[22:23], v[212:215]
    v_perm_b32 v22, v55, v51, s22
    v_perm_b32 v23, v63, v59, s22
    v_mfma_f32_16x16x16_bf16 v[216:219], v[14:15], v[20:21], v[216:219]
    s_nop 0
    v_mfma_f32_16x16x16_bf16 v[220:223], v[14:15], v[22:23], v[220:223]
K2_t14:
    s_bitcmp1_b32 s24, 4
    s_cbranch_scc0 K2_re10
    s_sub_u32 s31, s31, 1
    s_waitcnt lgkmcnt(0)
    v_readlane_b32 s29, v2, 2
    s_cmp_lt_u32 s31, 3
    v_add_u32 v6, v6, v4
    s_cbranch_scc1 K2_nl14
    buffer_load_dwordx4 v[48:51], v6, s[8:11], 0 offen offset:0
    buffer_load_dwordx4 v[52:55], v6, s[8:11], 0 offen offset:256
    buffer_load_dwordx4 v[56:59], v6, s[8:11], 0 offen offset:512
    buffer_load_dwordx4 v[60:63], v6, s[8:11], 0 offen offset:768
K2_nl14:
    v_add_lshl_u32 v5, s29, v3, 2
    ds_read_b32 v6, v5 offset:41088
    v_add_lshl_u32 v5, v2, v7, 4
    ds_read_b128 v[8:11], v5 offset:0
    s_cbranch_scc1 K2_wx14
    s_waitcnt vmcnt(12)
K2_wr14:
    v_perm_b32 v20, v68, v64, s21
    v_perm_b32 v21, v76, v72, s21
    v_perm_b32 v22, v68, v64, s22
    v_perm_b32 v23, v76, v72, s22
    v_mfma_f32_16x16x16_bf16 v[224:227], v[16:17], v[20:21], v[224:227]
    v_perm_b32 v20, v69, v65, s21
    v_perm_b32 v21, v77, v73, s21
    v_mfma_f32_16x16x16_bf16 v[228:231], v[16:17], v[22:23], v[228:231]
    v_perm_b32 v22, v69, v65, s22
    v_perm_b32 v23, v77, v73, s22
    v_mfma_f32_16x16x16_bf16 v[232:235], v[16:17], v[20:21], v[232:235]
    v_perm_b32 v20, v70, v66, s21
    v_perm_b32 v21, v78, v74, s21
    v_mfma_f32_16x16x16_bf16 v[236:239], v[16:17], v[22:23], v[236:239]
    v_perm_b32 v22, v70, v66, s22
    v_perm_b32 v23, v78, v74, s22
    v_mfma_f32_16x16x16_bf16 v[240:243], v[16:17], v[20:21], v[240:243]
    v_perm_b32 v20, v71, v67, s21
    v_perm_b32 v21, v79, v75, s21
    v_mfma_f32_16x16x16_bf16 v[244:247], v[16:17], v[22:23], v[244:247]
    v_perm_b32 v22, v71, v67, s22
    v_perm_b32 v23, v79, v75, s22
    v_mfma_f32_16x16x16_bf16 v[248:251], v[16:17], v[20:21], v[248:251]
    s_nop 0
    v_mfma_f32_16x16x16_bf16 v[252:255], v[16:17], v[22:23], v[252:255]
K2_re15:
    s_add_u32 s32, s32, 1
    s_lshr_b32 s34, s20, 2
    s_add_u32 s34, s34, s32
    s_setprio 0
    s_bitcmp1_b32 s34, 0
    s_cbranch_scc0 K2_pr15
    s_setprio 1
K2_pr15:
    s_lshr_b64 s[24:25], s[24:25], 8
    s_and_b32 s34, s32, 3
    s_cbranch_scc0 K2_rx15
K2_t15:
    s_bitcmp1_b32 s24, 0
    s_cbranch_scc0 K2_t11
    s_sub_u32 s31, s31, 1
    s_waitcnt lgkmcnt(0)
    v_readlane_b32 s29, v2, 3
    s_cmp_lt_u32 s31, 3
    v_add_u32 v6, v6, v4
    s_cbranch_scc1 K2_nl15
    buffer_load_dwordx4 v[64:67], v6, s[8:11], 0 offen offset:0
    buffer_load_dwordx4 v[68:71], v6, s[8:11], 0 offen offset:256
    buffer_load_dwordx4 v[72:75], v6, s[8:11], 0 offen offset:512
    buffer_load_dwordx4 v[76:79], v6, s[8:11], 0 offen offset:768
K2_nl15:
    v_add_lshl_u32 v5, s29, v3, 2
    ds_read_b32 v6, v5 offset:41088
    v_add_u32 v1, 16, v1
    ds_read_b32 v2, v1 offset:54720
    s_cbranch_scc1 K2_wx15
    s_waitcnt vmcnt(12)
K2_wr15:
    v_perm_b32 v20, v84, v80, s21
    v_perm_b32 v21, v92, v88, s21
    v_perm_b32 v22, v84, v80, s22
    v_perm_b32 v23, v92, v88, s22
    v_mfma_f32_16x16x16_bf16 v[96:99], v[18:19], v[20:21], v[96:99]
    v_perm_b32 v20, v85, v81, s21
    v_perm_b32 v21, v93, v89, s21
    v_mfma_f32_16x16x16_bf16 v[100:103], v[18:19], v[22:23], v[100:103]
    v_perm_b32 v22, v85, v81, s22
    v_perm_b32 v23, v93, v89, s22
    v_mfma_f32_16x16x16_bf16 v[104:107], v[18:19], v[20:21], v[104:107]
    v_perm_b32 v20, v86, v82, s21
    v_perm_b32 v21, v94, v90, s21
    v_mfma_f32_16x16x16_bf16 v[108:111], v[18:19], v[22:23], v[108:111]
    v_perm_b32 v22, v86, v82, s22
    v_perm_b32 v23, v94, v90, s22
    v_mfma_f32_16x16x16_bf16 v[112:115], v[18:19], v[20:21], v[112:115]
    v_perm_b32 v20, v87, v83, s21
    v_perm_b32 v21, v95, v91, s21
    v_mfma_f32_16x16x16_bf16 v[116:119], v[18:19], v[22:23], v[116:119]
    v_perm_b32 v22, v87, v83, s22
    v_perm_b32 v23, v95, v91, s22
    v_mfma_f32_16x16x16_bf16 v[120:123], v[18:19], v[20:21], v[120:123]
    s_nop 0
    v_mfma_f32_16x16x16_bf16 v[124:127], v[18:19], v[22:23], v[124:127]
K2_t16:
    s_bitcmp1_b32 s24, 1
    s_cbranch_scc0 K2_t12
    s_sub_u32 s31, s31, 1
    s_waitcnt lgkmcnt(0)
    v_readlane_b32 s29, v2, 0
    s_cmp_lt_u32 s31, 3
    v_perm_b32 v5, v9, v8, v0
    v_lshlrev_b32 v20, 16, v10
    v_and_b32 v21, 0xffff0000, v10
    v_lshlrev_b32 v22, 16, v11
    v_and_b32 v23, 0xffff0000, v11
    v_mul_f32 v20, v20, v5
    v_mul_f32 v21, v21, v5
    v_mul_f32 v22, v22, v5
    v_mul_f32 v23, v23, v5
    v_cvt_pk_bf16_f32 v8, v20, v21
    v_cvt_pk_bf16_f32 v9, v22, v23
    v_add_u32 v6, v6, v4
    s_nop 0
    v_mfma_f32_16x16x16_bf16 v[80:83], v[8:9], v[24:25], 0
    v_mfma_f32_16x16x16_bf16 v[84:87], v[8:9], v[26:27], 0
    v_mfma_f32_16x16x16_bf16 v[88:91], v[8:9], v[28:29], 0
    v_mfma_f32_16x16x16_bf16 v[92:95], v[8:9], v[30:31], 0
    s_cbranch_scc1 K2_wx16
    s_waitcnt vmcnt(8)
K2_wr16:
    v_perm_b32 v20, v36, v32, s21
    v_perm_b32 v21, v44, v40, s21
    v_perm_b32 v22, v36, v32, s22
    v_perm_b32 v23, v44, v40, s22
    s_nop 1
    v_cvt_pk_bf16_f32 v12, v80, v84
    v_cvt_pk_bf16_f32 v14, v81, v85
    v_cvt_pk_bf16_f32 v16, v82, v86
    v_cvt_pk_bf16_f32 v18, v83, v87
    v_cvt_pk_bf16_f32 v13, v88, v92
    v_cvt_pk_bf16_f32 v15, v89, v93
    v_cvt_pk_bf16_f32 v17, v90, v94
    v_cvt_pk_bf16_f32 v19, v91, v95
    s_cbranch_scc1 K2_nl16
    buffer_load_dwordx4 v[80:83], v6, s[8:11], 0 offen offset:0
    buffer_load_dwordx4 v[84:87], v6, s[8:11], 0 offen offset:256
    buffer_load_dwordx4 v[88:91], v6, s[8:11], 0 offen offset:512
    buffer_load_dwordx4 v[92:95], v6, s[8:11], 0 offen offset:768
K2_nl16:
    v_add_lshl_u32 v5, s29, v3, 2
    ds_read_b32 v6, v5 offset:41088
    v_mfma_f32_16x16x16_bf16 v[128:131], v[12:13], v[20:21], v[128:131]
    v_perm_b32 v20, v37, v33, s21
    v_perm_b32 v21, v45, v41, s21
    v_mfma_f32_16x16x16_bf16 v[132:135], v[12:13], v[22:23], v[132:135]
    v_perm_b32 v22, v37, v33, s22
    v_perm_b32 v23, v45, v41, s22
    v_mfma_f32_16x16x16_bf16 v[136:139], v[12:13], v[20:21], v[136:139]
    v_perm_b32 v20, v38, v34, s21
    v_perm_b32 v21, v46, v42, s21
    v_mfma_f32_16x16x16_bf16 v[140:143], v[12:13], v[22:23], v[140:143]
    v_perm_b32 v22, v38, v34, s22
    v_perm_b32 v23, v46, v42, s22
    v_mfma_f32_16x16x16_bf16 v[144:147], v[12:13], v[20:21], v[144:147]
    v_perm_b32 v20, v39, v35, s21
    v_perm_b32 v21, v47, v43, s21
    v_mfma_f32_16x16x16_bf16 v[148:151], v[12:13], v[22:23], v[148:151]
    v_perm_b32 v22, v39, v35, s22
    v_perm_b32 v23, v47, v43, s22
    v_mfma_f32_16x16x16_bf16 v[152:155], v[12:13], v[20:21], v[152:155]
    s_nop 0
    v_mfma_f32_16x16x16_bf16 v[156:159], v[12:13], v[22:23], v[156:159]
K2_t17:
    s_bitcmp1_b32 s24, 2
    s_cbranch_scc0 K2_t13
    s_sub_u32 s31, s31, 1
    s_waitcnt lgkmcnt(0)
    v_readlane_b32 s29, v2, 1
    s_cmp_lt_u32 s31, 3
    v_add_u32 v6, v6, v4
    s_cbranch_scc1 K2_nl17
    buffer_load_dwordx4 v[32:35], v6, s[8:11], 0 offen offset:0
    buffer_load_dwordx4 v[36:39], v6, s[8:11], 0 offen offset:256
    buffer_load_dwordx4 v[40:43], v6, s[8:11], 0 offen offset:512
    buffer_load_dwordx4 v[44:47], v6, s[8:11], 0 offen offset:768
K2_nl17:
    v_add_lshl_u32 v5, s29, v3, 2
    ds_read_b32 v6, v5 offset:41088
    s_cbranch_scc1 K2_wx17
    s_waitcnt vmcnt(12)
K2_wr17:
    v_perm_b32 v20, v52, v48, s21
    v_perm_b32 v21, v60, v56, s21
    v_perm_b32 v22, v52, v48, s22
    v_perm_b32 v23, v60, v56, s22
    v_mfma_f32_16x16x16_bf16 v[160:163], v[14:15], v[20:21], v[160:163]
    v_perm_b32 v20, v53, v49, s21
    v_perm_b32 v21, v61, v57, s21
    v_mfma_f32_16x16x16_bf16 v[164:167], v[14:15], v[22:23], v[164:167]
    v_perm_b32 v22, v53, v49, s22
    v_perm_b32 v23, v61, v57, s22
    v_mfma_f32_16x16x16_bf16 v[168:171], v[14:15], v[20:21], v[168:171]
    v_perm_b32 v20, v54, v50, s21
    v_perm_b32 v21, v62, v58, s21
    v_mfma_f32_16x16x16_bf16 v[172:175], v[14:15], v[22:23], v[172:175]
    v_perm_b32 v22, v54, v50, s22
    v_perm_b32 v23, v62, v58, s22
    v_mfma_f32_16x16x16_bf16 v[176:179], v[14:15], v[20:21], v[176:179]
    v_perm_b32 v20, v55, v51, s21
    v_perm_b32 v21, v63, v59, s21
    v_mfma_f32_16x16x16_bf16 v[180:183], v[14:15], v[22:23], v[180:183]
    v_perm_b32 v22, v55, v51, s22
    v_perm_b32 v23, v63, v59, s22
    v_mfma_f32_16x16x16_bf16 v[184:187], v[14:15], v[20:21], v[184:187]
    s_nop 0
    v_mfma_f32_16x16x16_bf16 v[188:191], v[14:15], v[22:23], v[188:191]
K2_t18:
    s_bitcmp1_b32 s24, 3
    s_cbranch_scc0 K2_t14
    s_sub_u32 s31, s31, 1
    s_waitcnt lgkmcnt(0)
    v_readlane_b32 s29, v2, 2
    s_cmp_lt_u32 s31, 3
    v_add_u32 v6, v6, v4
    s_cbranch_scc1 K2_nl18
    buffer_load_dwordx4 v[48:51], v6, s[8:11], 0 offen offset:0
    buffer_load_dwordx4 v[52:55], v6, s[8:11], 0 offen offset:256
    buffer_load_dwordx4 v[56:59], v6, s[8:11], 0 offen offset:512
    buffer_load_dwordx4 v[60:63], v6, s[8:11], 0 offen offset:768
K2_nl18:
    v_add_lshl_u32 v5, s29, v3, 2
    ds_read_b32 v6, v5 offset:41088
    v_add_lshl_u32 v5, v2, v7, 4
    ds_read_b128 v[8:11], v5 offset:0
    s_cbranch_scc1 K2_wx18
    s_waitcnt vmcnt(12)
K2_wr18:
    v_perm_b32 v20, v68, v64, s21
    v_perm_b32 v21, v76, v72, s21
    v_perm_b32 v22, v68, v64, s22
    v_perm_b32 v23, v76, v72, s22
    v_mfma_f32_16x16x16_bf16 v[192:195], v[16:17], v[20:21], v[192:195]
    v_perm_b32 v20, v69, v65, s21
    v_perm_b32 v21, v77, v73, s21
    v_mfma_f32_16x16x16_bf16 v[196:199], v[16:17], v[22:23], v[196:199]
    v_perm_b32 v22, v69, v65, s22
    v_perm_b32 v23, v77, v73, s22
    v_mfma_f32_16x16x16_bf16 v[200:203], v[16:17], v[20:21], v[200:203]
    v_perm_b32 v20, v70, v66, s21
    v_perm_b32 v21, v78, v74, s21
    v_mfma_f32_16x16x16_bf16 v[204:207], v[16:17], v[22:23], v[204:207]
    v_perm_b32 v22, v70, v66, s22
    v_perm_b32 v23, v78, v74, s22
    v_mfma_f32_16x16x16_bf16 v[208:211], v[16:17], v[20:21], v[208:211]
    v_perm_b32 v20, v71, v67, s21
    v_perm_b32 v21, v79, v75, s21
    v_mfma_f32_16x16x16_bf16 v[212:215], v[16:17], v[22:23], v[212:215]
    v_perm_b32 v22, v71, v67, s22
    v_perm_b32 v23, v79, v75, s22
    v_mfma_f32_16x16x16_bf16 v[216:219], v[16:17], v[20:21], v[216:219]
    s_nop 0
    v_mfma_f32_16x16x16_bf16 v[220:223], v[16:17], v[22:23], v[220:223]
K2_t19:
    s_bitcmp1_b32 s24, 4
    s_cbranch_scc0 K2_re15
    s_sub_u32 s31, s31, 1
    s_waitcnt lgkmcnt(0)
    v_readlane_b32 s29, v2, 3
    s_cmp_lt_u32 s31, 3
    v_add_u32 v6, v6, v4
    s_cbranch_scc1 K2_nl19
    buffer_load_dwordx4 v[64:67], v6, s[8:11], 0 offen offset:0
    buffer_load_dwordx4 v[68:71], v6, s[8:11], 0 offen offset:256
    buffer_load_dwordx4 v[72:75], v6, s[8:11], 0 offen offset:512
    buffer_load_dwordx4 v[76:79], v6, s[8:11], 0 offen offset:768
K2_nl19:
    v_add_lshl_u32 v5, s29, v3, 2
    ds_read_b32 v6, v5 offset:41088
    v_add_u32 v1, 16, v1
    ds_read_b32 v2, v1 offset:54720
    s_cbranch_scc1 K2_wx19
    s_waitcnt vmcnt(12)
K2_wr19:
    v_perm_b32 v20, v84, v80, s21
    v_perm_b32 v21, v92, v88, s21
    v_perm_b32 v22, v84, v80, s22
    v_perm_b32 v23, v92, v88, s22
    v_mfma_f32_16x16x16_bf16 v[224:227], v[18:19], v[20:21], v[224:227]
    v_perm_b32 v20, v85, v81, s21
    v_perm_b32 v21, v93, v89, s21
    v_mfma_f32_16x16x16_bf16 v[228:231], v[18:19], v[22:23], v[228:231]
    v_perm_b32 v22, v85, v81, s22
    v_perm_b32 v23, v93, v89, s22
    v_mfma_f32_16x16x16_bf16 v[232:235], v[18:19], v[20:21], v[232:235]
    v_perm_b32 v20, v86, v82, s21
    v_perm_b32 v21, v94, v90, s21
    v_mfma_f32_16x16x16_bf16 v[236:239], v[18:19], v[22:23], v[236:239]
    v_perm_b32 v22, v86, v82, s22
    v_perm_b32 v23, v94, v90, s22
    v_mfma_f32_16x16x16_bf16 v[240:243], v[18:19], v[20:21], v[240:243]
    v_perm_b32 v20, v87, v83, s21
    v_perm_b32 v21, v95, v91, s21
    v_mfma_f32_16x16x16_bf16 v[244:247], v[18:19], v[22:23], v[244:247]
    v_perm_b32 v22, v87, v83, s22
    v_perm_b32 v23, v95, v91, s22
    v_mfma_f32_16x16x16_bf16 v[248:251], v[18:19], v[20:21], v[248:251]
    s_nop 0
    v_mfma_f32_16x16x16_bf16 v[252:255], v[18:19], v[22:23], v[252:255]
    s_branch K2_re0
K2_lp0:
    s_waitcnt vmcnt(0)
    s_branch K2_ld_done
K2_lp1:
    s_waitcnt vmcnt(1)
    s_branch K2_ld_done
K2_lp2:
    s_waitcnt vmcnt(2)
    s_branch K2_ld_done
K2_lp3:
    s_waitcnt vmcnt(3)
    s_branch K2_ld_done
K2_lp4:
    s_waitcnt vmcnt(4)
    s_branch K2_ld_done
K2_lp5:
    s_waitcnt vmcnt(5)
    s_branch K2_ld_done
K2_lp6:
    s_waitcnt vmcnt(6)
    s_branch K2_ld_done
K2_lp7:
    s_waitcnt vmcnt(7)
    s_branch K2_ld_done
K2_lp8:
    s_waitcnt vmcnt(8)
    s_branch K2_ld_done
K2_lp9:
    s_waitcnt vmcnt(9)
    s_branch K2_ld_done
K2_rx0:
    s_cmp_eq_u32 s32, 16
    s_cbranch_scc1 K2_loop_done
    s_cmp_lg_u32 s32, 8
    s_cbranch_scc1 K2_ry0
    s_mov_b64 s[24:25], s[26:27]
    s_cmp_lg_u32 s30, s31
    s_cbranch_scc1 K2_ry0
    s_waitcnt vmcnt(0)
K2_ry0:
    s_cmp_lg_u32 s35, 0
    s_cbranch_scc1 K2_t0
    s_barrier
    s_branch K2_t0
K2_wx0:
    s_waitcnt vmcnt(8)
    s_cmp_eq_u32 s31, 2
    s_cbranch_scc1 K2_wr0
    s_waitcnt vmcnt(4)
    s_cmp_eq_u32 s31, 1
    s_cbranch_scc1 K2_wr0
    s_waitcnt vmcnt(0)
    s_cmp_eq_u32 s31, 0
    s_branch K2_wr0
K2_wx1:
    s_waitcnt vmcnt(8)
    s_cmp_eq_u32 s31, 2
    s_cbranch_scc1 K2_wr1
    s_waitcnt vmcnt(4)
    s_cmp_eq_u32 s31, 1
    s_cbranch_scc1 K2_wr1
    s_waitcnt vmcnt(0)
    s_cmp_eq_u32 s31, 0
    s_branch K2_wr1
K2_wx2:
    s_waitcnt vmcnt(8)
    s_cmp_eq_u32 s31, 2
    s_cbranch_scc1 K2_wr2
    s_waitcnt vmcnt(4)
    s_cmp_eq_u32 s31, 1
    s_cbranch_scc1 K2_wr2
    s_waitcnt vmcnt(0)
    s_cmp_eq_u32 s31, 0
    s_branch K2_wr2
K2_wx3:
    s_waitcnt vmcnt(8)
    s_cmp_eq_u32 s31, 2
    s_cbranch_scc1 K2_wr3
    s_waitcnt vmcnt(4)
    s_cmp_eq_u32 s31, 1
    s_cbranch_scc1 K2_wr3
    s_waitcnt vmcnt(0)
    s_cmp_eq_u32 s31, 0
    s_branch K2_wr3
K2_wx4:
    s_waitcnt vmcnt(8)
    s_cmp_eq_u32 s31, 2
    s_cbranch_scc1 K2_wr4
    s_waitcnt vmcnt(4)
    s_cmp_eq_u32 s31, 1
    s_cbranch_scc1 K2_wr4
    s_waitcnt vmcnt(0)
    s_cmp_eq_u32 s31, 0
    s_branch K2_wr4
K2_rx5:
    s_cmp_eq_u32 s32, 16
    s_cbranch_scc1 K2_loop_done
    s_cmp_lg_u32 s32, 8
    s_cbranch_scc1 K2_ry5
    s_mov_b64 s[24:25], s[26:27]
    s_cmp_lg_u32 s30, s31
    s_cbranch_scc1 K2_ry5
    s_waitcnt vmcnt(0)
K2_ry5:
    s_cmp_lg_u32 s35, 0
    s_cbranch_scc1 K2_t5
    s_barrier
    s_branch K2_t5
K2_wx5:
    s_waitcnt vmcnt(8)
    s_cmp_eq_u32 s31, 2
    s_cbranch_scc1 K2_wr5
    s_waitcnt vmcnt(4)
    s_cmp_eq_u32 s31, 1
    s_cbranch_scc1 K2_wr5
    s_waitcnt vmcnt(0)
    s_cmp_eq_u32 s31, 0
    s_branch K2_wr5
K2_wx6:
    s_waitcnt vmcnt(8)
    s_cmp_eq_u32 s31, 2
    s_cbranch_scc1 K2_wr6
    s_waitcnt vmcnt(4)
    s_cmp_eq_u32 s31, 1
    s_cbranch_scc1 K2_wr6
    s_waitcnt vmcnt(0)
    s_cmp_eq_u32 s31, 0
    s_branch K2_wr6
K2_wx7:
    s_waitcnt vmcnt(8)
    s_cmp_eq_u32 s31, 2
    s_cbranch_scc1 K2_wr7
    s_waitcnt vmcnt(4)
    s_cmp_eq_u32 s31, 1
    s_cbranch_scc1 K2_wr7
    s_waitcnt vmcnt(0)
    s_cmp_eq_u32 s31, 0
    s_branch K2_wr7
K2_wx8:
    s_waitcnt vmcnt(8)
    s_cmp_eq_u32 s31, 2
    s_cbranch_scc1 K2_wr8
    s_waitcnt vmcnt(4)
    s_cmp_eq_u32 s31, 1
    s_cbranch_scc1 K2_wr8
    s_waitcnt vmcnt(0)
    s_cmp_eq_u32 s31, 0
    s_branch K2_wr8
K2_wx9:
    s_waitcnt vmcnt(8)
    s_cmp_eq_u32 s31, 2
    s_cbranch_scc1 K2_wr9
    s_waitcnt vmcnt(4)
    s_cmp_eq_u32 s31, 1
    s_cbranch_scc1 K2_wr9
    s_waitcnt vmcnt(0)
    s_cmp_eq_u32 s31, 0
    s_branch K2_wr9
K2_rx10:
    s_cmp_eq_u32 s32, 16
    s_cbranch_scc1 K2_loop_done
    s_cmp_lg_u32 s32, 8
    s_cbranch_scc1 K2_ry10
    s_mov_b64 s[24:25], s[26:27]
    s_cmp_lg_u32 s30, s31
    s_cbranch_scc1 K2_ry10
    s_waitcnt vmcnt(0)
K2_ry10:
    s_cmp_lg_u32 s35, 0
    s_cbranch_scc1 K2_t10
    s_barrier
    s_branch K2_t10
K2_wx10:
    s_waitcnt vmcnt(8)
    s_cmp_eq_u32 s31, 2
    s_cbranch_scc1 K2_wr10
    s_waitcnt vmcnt(4)
    s_cmp_eq_u32 s31, 1
    s_cbranch_scc1 K2_wr10
    s_waitcnt vmcnt(0)
    s_cmp_eq_u32 s31, 0
    s_branch K2_wr10
K2_wx11:
    s_waitcnt vmcnt(8)
    s_cmp_eq_u32 s31, 2
    s_cbranch_scc1 K2_wr11
    s_waitcnt vmcnt(4)
    s_cmp_eq_u32 s31, 1
    s_cbranch_scc1 K2_wr11
    s_waitcnt vmcnt(0)
    s_cmp_eq_u32 s31, 0
    s_branch K2_wr11
K2_wx12:
    s_waitcnt vmcnt(8)
    s_cmp_eq_u32 s31, 2
    s_cbranch_scc1 K2_wr12
    s_waitcnt vmcnt(4)
    s_cmp_eq_u32 s31, 1
    s_cbranch_scc1 K2_wr12
    s_waitcnt vmcnt(0)
    s_cmp_eq_u32 s31, 0
    s_branch K2_wr12
K2_wx13:
    s_waitcnt vmcnt(8)
    s_cmp_eq_u32 s31, 2
    s_cbranch_scc1 K2_wr13
    s_waitcnt vmcnt(4)
    s_cmp_eq_u32 s31, 1
    s_cbranch_scc1 K2_wr13
    s_waitcnt vmcnt(0)
    s_cmp_eq_u32 s31, 0
    s_branch K2_wr13
K2_wx14:
    s_waitcnt vmcnt(8)
    s_cmp_eq_u32 s31, 2
    s_cbranch_scc1 K2_wr14
    s_waitcnt vmcnt(4)
    s_cmp_eq_u32 s31, 1
    s_cbranch_scc1 K2_wr14
    s_waitcnt vmcnt(0)
    s_cmp_eq_u32 s31, 0
    s_branch K2_wr14
K2_rx15:
    s_cmp_eq_u32 s32, 16
    s_cbranch_scc1 K2_loop_done
    s_cmp_lg_u32 s32, 8
    s_cbranch_scc1 K2_ry15
    s_mov_b64 s[24:25], s[26:27]
    s_cmp_lg_u32 s30, s31
    s_cbranch_scc1 K2_ry15
    s_waitcnt vmcnt(0)
K2_ry15:
    s_cmp_lg_u32 s35, 0
    s_cbranch_scc1 K2_t15
    s_barrier
    s_branch K2_t15
K2_wx15:
    s_waitcnt vmcnt(8)
    s_cmp_eq_u32 s31, 2
    s_cbranch_scc1 K2_wr15
    s_waitcnt vmcnt(4)
    s_cmp_eq_u32 s31, 1
    s_cbranch_scc1 K2_wr15
    s_waitcnt vmcnt(0)
    s_cmp_eq_u32 s31, 0
    s_branch K2_wr15
K2_wx16:
    s_waitcnt vmcnt(8)
    s_cmp_eq_u32 s31, 2
    s_cbranch_scc1 K2_wr16
    s_waitcnt vmcnt(4)
    s_cmp_eq_u32 s31, 1
    s_cbranch_scc1 K2_wr16
    s_waitcnt vmcnt(0)
    s_cmp_eq_u32 s31, 0
    s_branch K2_wr16
K2_wx17:
    s_waitcnt vmcnt(8)
    s_cmp_eq_u32 s31, 2
    s_cbranch_scc1 K2_wr17
    s_waitcnt vmcnt(4)
    s_cmp_eq_u32 s31, 1
    s_cbranch_scc1 K2_wr17
    s_waitcnt vmcnt(0)
    s_cmp_eq_u32 s31, 0
    s_branch K2_wr17
K2_wx18:
    s_waitcnt vmcnt(8)
    s_cmp_eq_u32 s31, 2
    s_cbranch_scc1 K2_wr18
    s_waitcnt vmcnt(4)
    s_cmp_eq_u32 s31, 1
    s_cbranch_scc1 K2_wr18
    s_waitcnt vmcnt(0)
    s_cmp_eq_u32 s31, 0
    s_branch K2_wr18
K2_wx19:
    s_waitcnt vmcnt(8)
    s_cmp_eq_u32 s31, 2
    s_cbranch_scc1 K2_wr19
    s_waitcnt vmcnt(4)
    s_cmp_eq_u32 s31, 1
    s_cbranch_scc1 K2_wr19
    s_waitcnt vmcnt(0)
    s_cmp_eq_u32 s31, 0
    s_branch K2_wr19
K2_loop_done:
    s_cmp_lg_u32 s36, 0
    s_cbranch_scc1 K2_slow_next
K2_epi:
    s_waitcnt vmcnt(0) lgkmcnt(0)
    v_mbcnt_lo_u32_b32 v22, -1, 0
    v_mbcnt_hi_u32_b32 v22, -1, v22
    s_and_b32 s3, s20, 3
    s_lshl_b32 s4, s3, 13
    v_lshlrev_b32 v2, 4, v22
    s_add_u32 s4, s4, 6662144
    buffer_load_dwordx4 v[64:67], v2, s[12:15], s4 offen offset:0
    buffer_load_dwordx4 v[68:71], v2, s[12:15], s4 offen offset:1024
    buffer_load_dwordx4 v[72:75], v2, s[12:15], s4 offen offset:2048
    buffer_load_dwordx4 v[76:79], v2, s[12:15], s4 offen offset:3072
    s_add_u32 s4, s4, 4096
    buffer_load_dwordx4 v[80:83], v2, s[12:15], s4 offen offset:0
    buffer_load_dwordx4 v[84:87], v2, s[12:15], s4 offen offset:1024
    buffer_load_dwordx4 v[88:91], v2, s[12:15], s4 offen offset:2048
    buffer_load_dwordx4 v[92:95], v2, s[12:15], s4 offen offset:3072
    v_add_u32 v1, 91648, v4
    ds_read_b128 v[32:35], v1 offset:0
    ds_read_b128 v[36:39], v1 offset:256
    ds_read_b128 v[40:43], v1 offset:512
    ds_read_b128 v[44:47], v1 offset:768
    ds_read_b128 v[48:51], v1 offset:1024
    ds_read_b128 v[52:55], v1 offset:1280
    ds_read_b128 v[56:59], v1 offset:1536
    ds_read_b128 v[60:63], v1 offset:1792
    s_lshl_b32 s5, s20, 6
    v_mov_b32 v5, s5
    ds_read_b128 v[16:19], v5 offset:53168
    ds_read_b32 v20, v5 offset:53184
    v_mul_u32_u24 v2, 272, v3
    v_add_u32 v2, v2, v4
    v_add_u32 v2, 93696, v2
    s_mov_b32 s4, 1088
    s_waitcnt lgkmcnt(0)
    v_and_b32 v16, 0xff, v16
    v_mad_u32_u24 v16, v16, s4, v2
    v_and_b32 v17, 0xff, v17
    v_mad_u32_u24 v17, v17, s4, v2
    v_and_b32 v18, 0xff, v18
    v_mad_u32_u24 v18, v18, s4, v2
    v_and_b32 v19, 0xff, v19
    v_mad_u32_u24 v19, v19, s4, v2
    v_and_b32 v20, 0xff, v20
    v_mad_u32_u24 v20, v20, s4, v2
    v_mul_f32 v96, v96, v32
    v_mul_f32 v100, v100, v36
    v_mul_f32 v104, v104, v40
    v_mul_f32 v108, v108, v44
    v_mul_f32 v112, v112, v48
    v_mul_f32 v116, v116, v52
    v_mul_f32 v120, v120, v56
    v_mul_f32 v124, v124, v60
    v_fmac_f32 v96, v97, v33
    v_fmac_f32 v100, v101, v37
    v_fmac_f32 v104, v105, v41
    v_fmac_f32 v108, v109, v45
    v_fmac_f32 v112, v113, v49
    v_fmac_f32 v116, v117, v53
    v_fmac_f32 v120, v121, v57
    v_fmac_f32 v124, v125, v61
    v_fmac_f32 v96, v98, v34
    v_fmac_f32 v100, v102, v38
    v_fmac_f32 v104, v106, v42
    v_fmac_f32 v108, v110, v46
    v_fmac_f32 v112, v114, v50
    v_fmac_f32 v116, v118, v54
    v_fmac_f32 v120, v122, v58
    v_fmac_f32 v124, v126, v62
    v_fmac_f32 v96, v99, v35
    v_fmac_f32 v100, v103, v39
    v_fmac_f32 v104, v107, v43
    v_fmac_f32 v108, v111, v47
    v_fmac_f32 v112, v115, v51
    v_fmac_f32 v116, v119, v55
    v_fmac_f32 v120, v123, v59
    v_fmac_f32 v124, v127, v63
    v_cvt_pk_bf16_f32 v8, v96, v100
    v_cvt_pk_bf16_f32 v9, v104, v108
    v_cvt_pk_bf16_f32 v10, v112, v116
    v_cvt_pk_bf16_f32 v11, v120, v124
    ds_write_b128 v16, v[8:11]
    v_mul_f32 v128, v128, v32
    v_mul_f32 v132, v132, v36
    v_mul_f32 v136, v136, v40
    v_mul_f32 v140, v140, v44
    v_mul_f32 v144, v144, v48
    v_mul_f32 v148, v148, v52
    v_mul_f32 v152, v152, v56
    v_mul_f32 v156, v156, v60
    v_fmac_f32 v128, v129, v33
    v_fmac_f32 v132, v133, v37
    v_fmac_f32 v136, v137, v41
    v_fmac_f32 v140, v141, v45
    v_fmac_f32 v144, v145, v49
    v_fmac_f32 v148, v149, v53
    v_fmac_f32 v152, v153, v57
    v_fmac_f32 v156, v157, v61
    v_fmac_f32 v128, v130, v34
    v_fmac_f32 v132, v134, v38
    v_fmac_f32 v136, v138, v42
    v_fmac_f32 v140, v142, v46
    v_fmac_f32 v144, v146, v50
    v_fmac_f32 v148, v150, v54
    v_fmac_f32 v152, v154, v58
    v_fmac_f32 v156, v158, v62
    v_fmac_f32 v128, v131, v35
    v_fmac_f32 v132, v135, v39
    v_fmac_f32 v136, v139, v43
    v_fmac_f32 v140, v143, v47
    v_fmac_f32 v144, v147, v51
    v_fmac_f32 v148, v151, v55
    v_fmac_f32 v152, v155, v59
    v_fmac_f32 v156, v159, v63
    v_cvt_pk_bf16_f32 v12, v128, v132
    v_cvt_pk_bf16_f32 v13, v136, v140
    v_cvt_pk_bf16_f32 v14, v144, v148
    v_cvt_pk_bf16_f32 v15, v152, v156
    ds_write_b128 v17, v[12:15]
    v_mul_f32 v160, v160, v32
    v_mul_f32 v164, v164, v36
    v_mul_f32 v168, v168, v40
    v_mul_f32 v172, v172, v44
    v_mul_f32 v176, v176, v48
    v_mul_f32 v180, v180, v52
    v_mul_f32 v184, v184, v56
    v_mul_f32 v188, v188, v60
    v_fmac_f32 v160, v161, v33
    v_fmac_f32 v164, v165, v37
    v_fmac_f32 v168, v169, v41
    v_fmac_f32 v172, v173, v45
    v_fmac_f32 v176, v177, v49
    v_fmac_f32 v180, v181, v53
    v_fmac_f32 v184, v185, v57
    v_fmac_f32 v188, v189, v61
    v_fmac_f32 v160, v162, v34
    v_fmac_f32 v164, v166, v38
    v_fmac_f32 v168, v170, v42
    v_fmac_f32 v172, v174, v46
    v_fmac_f32 v176, v178, v50
    v_fmac_f32 v180, v182, v54
    v_fmac_f32 v184, v186, v58
    v_fmac_f32 v188, v190, v62
    v_fmac_f32 v160, v163, v35
    v_fmac_f32 v164, v167, v39
    v_fmac_f32 v168, v171, v43
    v_fmac_f32 v172, v175, v47
    v_fmac_f32 v176, v179, v51
    v_fmac_f32 v180, v183, v55
    v_fmac_f32 v184, v187, v59
    v_fmac_f32 v188, v191, v63
    v_cvt_pk_bf16_f32 v8, v160, v164
    v_cvt_pk_bf16_f32 v9, v168, v172
    v_cvt_pk_bf16_f32 v10, v176, v180
    v_cvt_pk_bf16_f32 v11, v184, v188
    ds_write_b128 v18, v[8:11]
    v_mul_f32 v192, v192, v32
    v_mul_f32 v196, v196, v36
    v_mul_f32 v200, v200, v40
    v_mul_f32 v204, v204, v44
    v_mul_f32 v208, v208, v48
    v_mul_f32 v212, v212, v52
    v_mul_f32 v216, v216, v56
    v_mul_f32 v220, v220, v60
    v_fmac_f32 v192, v193, v33
    v_fmac_f32 v196, v197, v37
    v_fmac_f32 v200, v201, v41
    v_fmac_f32 v204, v205, v45
    v_fmac_f32 v208, v209, v49
    v_fmac_f32 v212, v213, v53
    v_fmac_f32 v216, v217, v57
    v_fmac_f32 v220, v221, v61
    v_fmac_f32 v192, v194, v34
    v_fmac_f32 v196, v198, v38
    v_fmac_f32 v200, v202, v42
    v_fmac_f32 v204, v206, v46
    v_fmac_f32 v208, v210, v50
    v_fmac_f32 v212, v214, v54
    v_fmac_f32 v216, v218, v58
    v_fmac_f32 v220, v222, v62
    v_fmac_f32 v192, v195, v35
    v_fmac_f32 v196, v199, v39
    v_fmac_f32 v200, v203, v43
    v_fmac_f32 v204, v207, v47
    v_fmac_f32 v208, v211, v51
    v_fmac_f32 v212, v215, v55
    v_fmac_f32 v216, v219, v59
    v_fmac_f32 v220, v223, v63
    v_cvt_pk_bf16_f32 v12, v192, v196
    v_cvt_pk_bf16_f32 v13, v200, v204
    v_cvt_pk_bf16_f32 v14, v208, v212
    v_cvt_pk_bf16_f32 v15, v216, v220
    ds_write_b128 v19, v[12:15]
    v_mul_f32 v224, v224, v32
    v_mul_f32 v228, v228, v36
    v_mul_f32 v232, v232, v40
    v_mul_f32 v236, v236, v44
    v_mul_f32 v240, v240, v48
    v_mul_f32 v244, v244, v52
    v_mul_f32 v248, v248, v56
    v_mul_f32 v252, v252, v60
    v_fmac_f32 v224, v225, v33
    v_fmac_f32 v228, v229, v37
    v_fmac_f32 v232, v233, v41
    v_fmac_f32 v236, v237, v45
    v_fmac_f32 v240, v241, v49
    v_fmac_f32 v244, v245, v53
    v_fmac_f32 v248, v249, v57
    v_fmac_f32 v252, v253, v61
    v_fmac_f32 v224, v226, v34
    v_fmac_f32 v228, v230, v38
    v_fmac_f32 v232, v234, v42
    v_fmac_f32 v236, v238, v46
    v_fmac_f32 v240, v242, v50
    v_fmac_f32 v244, v246, v54
    v_fmac_f32 v248, v250, v58
    v_fmac_f32 v252, v254, v62
    v_fmac_f32 v224, v227, v35
    v_fmac_f32 v228, v231, v39
    v_fmac_f32 v232, v235, v43
    v_fmac_f32 v236, v239, v47
    v_fmac_f32 v240, v243, v51
    v_fmac_f32 v244, v247, v55
    v_fmac_f32 v248, v251, v59
    v_fmac_f32 v252, v255, v63
    v_cvt_pk_bf16_f32 v8, v224, v228
    v_cvt_pk_bf16_f32 v9, v232, v236
    v_cvt_pk_bf16_f32 v10, v240, v244
    v_cvt_pk_bf16_f32 v11, v248, v252
    ds_write_b128 v20, v[8:11]
    s_lshr_b32 s5, s20, 2
    s_mul_i32 s6, s5, 4352
    s_add_u32 s6, s6, 93696
    v_and_b32 v6, 15, v22
    v_mul_u32_u24 v7, 272, v6
    v_lshl_add_u32 v7, v3, 4, v7
    v_add_u32 v7, s6, v7
    v_lshlrev_b32 v5, 8, v6
    v_lshl_add_u32 v5, v3, 4, v5
    s_mul_i32 s6, s39, 625
    s_add_u32 s7, s6, 640
    s_add_u32 s6, s6, 15
    s_lshr_b32 s6, s6, 4
    s_lshr_b32 s7, s7, 4
    s_sub_u32 s7, s7, s6
    s_lshl_b32 s7, s7, 2
    s_lshl_b32 s4, s5, 4
    s_sub_u32 s7, s7, s4
    s_sub_u32 s7, s7, 128
    v_mov_b32 v21, 2130706432
    v_cmp_gt_u32 vcc, s7, v6
    s_lshl_b32 s6, s6, 10
    s_nop 0
    v_cndmask_b32 v21, v21, v5, vcc
    s_lshl_b32 s7, s5, 12
    s_add_u32 s6, s6, s7
    s_lshl_b32 s7, s3, 6
    s_add_u32 s6, s6, s7
    s_waitcnt lgkmcnt(0)
    s_barrier
    ds_read_b128 v[96:99], v7 offset:0
    ds_read_b128 v[100:103], v7 offset:64
    ds_read_b128 v[104:107], v7 offset:128
    ds_read_b128 v[108:111], v7 offset:192
    ds_read_b128 v[112:115], v7 offset:8704
    ds_read_b128 v[116:119], v7 offset:8768
    ds_read_b128 v[120:123], v7 offset:8832
    ds_read_b128 v[124:127], v7 offset:8896
    s_waitcnt vmcnt(0)
    s_waitcnt lgkmcnt(7)
    v_mfma_f32_16x16x32_bf16 v[176:179], v[64:67], v[96:99], 0
    v_mfma_f32_16x16x32_bf16 v[180:183], v[80:83], v[96:99], 0
    s_waitcnt lgkmcnt(6)
    v_mfma_f32_16x16x32_bf16 v[176:179], v[68:71], v[100:103], v[176:179]
    v_mfma_f32_16x16x32_bf16 v[180:183], v[84:87], v[100:103], v[180:183]
    s_waitcnt lgkmcnt(5)
    v_mfma_f32_16x16x32_bf16 v[176:179], v[72:75], v[104:107], v[176:179]
    v_mfma_f32_16x16x32_bf16 v[180:183], v[88:91], v[104:107], v[180:183]
    s_waitcnt lgkmcnt(4)
    v_mfma_f32_16x16x32_bf16 v[176:179], v[76:79], v[108:111], v[176:179]
    v_mfma_f32_16x16x32_bf16 v[180:183], v[92:95], v[108:111], v[180:183]
    ds_read_b128 v[128:131], v7 offset:17408
    ds_read_b128 v[132:135], v7 offset:17472
    ds_read_b128 v[136:139], v7 offset:17536
    ds_read_b128 v[140:143], v7 offset:17600
    s_waitcnt lgkmcnt(7)
    v_mfma_f32_16x16x32_bf16 v[184:187], v[64:67], v[112:115], 0
    v_mfma_f32_16x16x32_bf16 v[188:191], v[80:83], v[112:115], 0
    s_waitcnt lgkmcnt(6)
    v_mfma_f32_16x16x32_bf16 v[184:187], v[68:71], v[116:119], v[184:187]
    v_mfma_f32_16x16x32_bf16 v[188:191], v[84:87], v[116:119], v[188:191]
    s_waitcnt lgkmcnt(5)
    v_mfma_f32_16x16x32_bf16 v[184:187], v[72:75], v[120:123], v[184:187]
    v_mfma_f32_16x16x32_bf16 v[188:191], v[88:91], v[120:123], v[188:191]
    s_waitcnt lgkmcnt(4)
    v_mfma_f32_16x16x32_bf16 v[184:187], v[76:79], v[124:127], v[184:187]
    v_mfma_f32_16x16x32_bf16 v[188:191], v[92:95], v[124:127], v[188:191]
    ds_read_b128 v[144:147], v7 offset:26112
    ds_read_b128 v[148:151], v7 offset:26176
    ds_read_b128 v[152:155], v7 offset:26240
    ds_read_b128 v[156:159], v7 offset:26304
    v_cvt_pk_bf16_f32 v216, v176, v177
    v_cvt_pk_bf16_f32 v217, v178, v179
    v_cvt_pk_bf16_f32 v218, v180, v181
    v_cvt_pk_bf16_f32 v219, v182, v183
    buffer_store_dwordx4 v[216:219], v5, s[16:19], s6 offen sc0 sc1
    s_add_u32 s6, s6, 8192
    s_waitcnt lgkmcnt(7)
    v_mfma_f32_16x16x32_bf16 v[192:195], v[64:67], v[128:131], 0
    v_mfma_f32_16x16x32_bf16 v[196:199], v[80:83], v[128:131], 0
    s_waitcnt lgkmcnt(6)
    v_mfma_f32_16x16x32_bf16 v[192:195], v[68:71], v[132:135], v[192:195]
    v_mfma_f32_16x16x32_bf16 v[196:199], v[84:87], v[132:135], v[196:199]
    s_waitcnt lgkmcnt(5)
    v_mfma_f32_16x16x32_bf16 v[192:195], v[72:75], v[136:139], v[192:195]
    v_mfma_f32_16x16x32_bf16 v[196:199], v[88:91], v[136:139], v[196:199]
    s_waitcnt lgkmcnt(4)
    v_mfma_f32_16x16x32_bf16 v[192:195], v[76:79], v[140:143], v[192:195]
    v_mfma_f32_16x16x32_bf16 v[196:199], v[92:95], v[140:143], v[196:199]
    ds_read_b128 v[160:163], v7 offset:34816
    ds_read_b128 v[164:167], v7 offset:34880
    ds_read_b128 v[168:171], v7 offset:34944
    ds_read_b128 v[172:175], v7 offset:35008
    v_cvt_pk_bf16_f32 v220, v184, v185
    v_cvt_pk_bf16_f32 v221, v186, v187
    v_cvt_pk_bf16_f32 v222, v188, v189
    v_cvt_pk_bf16_f32 v223, v190, v191
    buffer_store_dwordx4 v[220:223], v5, s[16:19], s6 offen sc0 sc1
    s_add_u32 s6, s6, 8192
    s_waitcnt lgkmcnt(7)
    v_mfma_f32_16x16x32_bf16 v[200:203], v[64:67], v[144:147], 0
    v_mfma_f32_16x16x32_bf16 v[204:207], v[80:83], v[144:147], 0
    s_waitcnt lgkmcnt(6)
    v_mfma_f32_16x16x32_bf16 v[200:203], v[68:71], v[148:151], v[200:203]
    v_mfma_f32_16x16x32_bf16 v[204:207], v[84:87], v[148:151], v[204:207]
    s_waitcnt lgkmcnt(5)
    v_mfma_f32_16x16x32_bf16 v[200:203], v[72:75], v[152:155], v[200:203]
    v_mfma_f32_16x16x32_bf16 v[204:207], v[88:91], v[152:155], v[204:207]
    s_waitcnt lgkmcnt(4)
    v_mfma_f32_16x16x32_bf16 v[200:203], v[76:79], v[156:159], v[200:203]
    v_mfma_f32_16x16x32_bf16 v[204:207], v[92:95], v[156:159], v[204:207]
    v_cvt_pk_bf16_f32 v224, v192, v193
    v_cvt_pk_bf16_f32 v225, v194, v195
    v_cvt_pk_bf16_f32 v226, v196, v197
    v_cvt_pk_bf16_f32 v227, v198, v199
    buffer_store_dwordx4 v[224:227], v5, s[16:19], s6 offen sc0 sc1
    s_add_u32 s6, s6, 8192
    s_waitcnt lgkmcnt(3)
    v_mfma_f32_16x16x32_bf16 v[208:211], v[64:67], v[160:163], 0
    v_mfma_f32_16x16x32_bf16 v[212:215], v[80:83], v[160:163], 0
    s_waitcnt lgkmcnt(2)
    v_mfma_f32_16x16x32_bf16 v[208:211], v[68:71], v[164:167], v[208:211]
    v_mfma_f32_16x16x32_bf16 v[212:215], v[84:87], v[164:167], v[212:215]
    s_waitcnt lgkmcnt(1)
    v_mfma_f32_16x16x32_bf16 v[208:211], v[72:75], v[168:171], v[208:211]
    v_mfma_f32_16x16x32_bf16 v[212:215], v[88:91], v[168:171], v[212:215]
    s_waitcnt lgkmcnt(0)
    v_mfma_f32_16x16x32_bf16 v[208:211], v[76:79], v[172:175], v[208:211]
    v_mfma_f32_16x16x32_bf16 v[212:215], v[92:95], v[172:175], v[212:215]
    v_cvt_pk_bf16_f32 v228, v200, v201
    v_cvt_pk_bf16_f32 v229, v202, v203
    v_cvt_pk_bf16_f32 v230, v204, v205
    v_cvt_pk_bf16_f32 v231, v206, v207
    buffer_store_dwordx4 v[228:231], v5, s[16:19], s6 offen sc0 sc1
    s_add_u32 s6, s6, 8192
    s_nop 7
    v_cvt_pk_bf16_f32 v232, v208, v209
    v_cvt_pk_bf16_f32 v233, v210, v211
    v_cvt_pk_bf16_f32 v234, v212, v213
    v_cvt_pk_bf16_f32 v235, v214, v215
    buffer_store_dwordx4 v[232:235], v21, s[16:19], s6 offen sc0 sc1
    s_add_u32 s6, s6, 8192
K2_end:
    s_endpgm
K2_slow:
    s_mov_b32 s36, 1
    s_mov_b32 s37, 0
    v_lshlrev_b32 v8, 10, v22
    s_lshl_b32 s3, s39, 2
    s_add_u32 s3, s3, 6400000
    buffer_load_dword v10, v8, s[12:15], s3 offen
    s_add_u32 s3, s3, 65536
    buffer_load_dword v12, v8, s[12:15], s3 offen
    s_add_u32 s3, s3, 65536
    buffer_load_dword v14, v8, s[12:15], s3 offen
    s_add_u32 s3, s3, 65536
    buffer_load_dword v16, v8, s[12:15], s3 offen
    s_add_u32 s3, s3, 65536
    v_cmp_gt_u32 vcc, 58, v22
    s_waitcnt vmcnt(0)
    v_lshrrev_b32 v10, 16, v10
    v_lshrrev_b32 v12, 16, v12
    v_lshrrev_b32 v14, 16, v14
    v_lshrrev_b32 v16, 16, v16
    v_cndmask_b32 v16, 0, v16, vcc
    v_max_u32 v10, v10, v12
    v_max3_u32 v10, v10, v14, v16
    s_nop 1
    v_max_u32_dpp v10, v10, v10 row_shr:1 row_mask:0xf bank_mask:0xf
    s_nop 1
    v_max_u32_dpp v10, v10, v10 row_shr:2 row_mask:0xf bank_mask:0xf
    s_nop 1
    v_max_u32_dpp v10, v10, v10 row_shr:4 row_mask:0xf bank_mask:0xf
    s_nop 1
    v_max_u32_dpp v10, v10, v10 row_shr:8 row_mask:0xf bank_mask:0xf
    s_nop 1
    v_max_u32_dpp v10, v10, v10 row_bcast:15 row_mask:0xa bank_mask:0xf
    s_nop 1
    v_max_u32_dpp v10, v10, v10 row_bcast:31 row_mask:0xc bank_mask:0xf
    s_nop 1
    v_readlane_b32 s38, v10, 63
K2_slow_win:
    s_cmp_ge_u32 s37, s38
    s_cbranch_scc1 K2_slow_fin
    v_mbcnt_lo_u32_b32 v22, -1, 0
    v_mbcnt_hi_u32_b32 v22, -1, v22
    s_lshl_b32 s3, s20, 6
    v_add_u32 v23, s3, v22
    v_lshrrev_b32 v8, 1, v23
    v_and_b32 v9, 1, v23
    v_lshlrev_b32 v10, 10, v8
    s_lshl_b32 s3, s39, 2
    s_add_u32 s3, s3, 6400000
    buffer_load_dword v12, v10, s[12:15], s3 offen
    v_mul_u32_u24 v10, 1280, v8
    v_add3_u32 v10, v10, v9, s37
    v_cmp_gt_u32 vcc, 250, v8
    s_waitcnt vmcnt(0)
    v_lshrrev_b32 v11, 16, v12
    v_and_b32 v12, 0xffff, v12
    v_cndmask_b32 v11, 0, v11, vcc
    v_add_u32 v10, v10, v12
    v_sub_u32 v13, v11, v9
    v_subrev_u32 v13, s37, v13
    v_lshlrev_b32 v14, 4, v10
    v_lshlrev_b32 v10, 2, v10
    v_cmp_lt_i32 s[40:41], 0, v13
    v_cmp_lt_i32 s[42:43], 2, v13
    v_cmp_lt_i32 s[44:45], 4, v13
    v_cmp_lt_i32 s[46:47], 6, v13
    v_cmp_lt_i32 s[48:49], 8, v13
    v_cmp_lt_i32 s[50:51], 10, v13
    v_cmp_lt_i32 s[52:53], 12, v13
    v_cmp_lt_i32 s[54:55], 14, v13
    v_cmp_lt_i32 s[56:57], 16, v13
    v_cmp_lt_i32 s[58:59], 18, v13
K2_slow_batch:
    s_waitcnt vmcnt(0) lgkmcnt(0)
    s_barrier
    v_mbcnt_lo_u32_b32 v22, -1, 0
    v_mbcnt_hi_u32_b32 v22, -1, v22
    s_lshl_b32 s3, s20, 6
    v_add_u32 v23, s3, v22
    v_lshrrev_b32 v8, 1, v23
    v_and_b32 v9, 1, v23
    v_lshlrev_b32 v10, 10, v8
    s_lshl_b32 s3, s39, 2
    s_add_u32 s3, s3, 6400000
    buffer_load_dword v12, v10, s[12:15], s3 offen
    v_mul_u32_u24 v10, 1280, v8
    v_add3_u32 v10, v10, v9, s37
    v_cmp_gt_u32 vcc, 250, v8
    s_waitcnt vmcnt(0)
    v_lshrrev_b32 v11, 16, v12
    v_and_b32 v12, 0xffff, v12
    v_cndmask_b32 v11, 0, v11, vcc
    v_add_u32 v10, v10, v12
    v_sub_u32 v13, v11, v9
    v_subrev_u32 v13, s37, v13
    v_lshlrev_b32 v14, 4, v10
    v_lshlrev_b32 v10, 2, v10
    v_lshlrev_b32 v8, 2, v23
    v_mov_b32 v9, 0
    v_cmp_gt_u32 vcc, 164, v23
    s_and_saveexec_b64 s[60:61], vcc
    ds_write_b32 v8, v9 offset:51360
    s_mov_b64 exec, -1
    s_waitcnt lgkmcnt(0)
    s_barrier
    v_mov_b32 v17, 1
    s_mov_b32 s3, 5120000
    s_mov_b64 s[60:61], 0
    s_mov_b64 exec, s[40:41]
    s_cbranch_execz K2_slow_skip0
    buffer_load_dword v16, v10, s[12:15], s3 offen offset:0
    buffer_load_dwordx4 v[32:35], v14, s[12:15], 0 offen offset:0
    s_waitcnt vmcnt(0)
    v_bfe_u32 v8, v16, 4, 6
    v_lshlrev_b32 v9, 4, v8
    ds_add_rtn_u32 v15, v9, v17 offset:51360
    v_and_b32 v16, 0xfffc00, v16
    s_waitcnt lgkmcnt(0)
    v_cmp_gt_u32 vcc, 64, v15
    s_andn2_b64 s[40:41], s[40:41], vcc
    s_or_b64 s[60:61], s[60:61], s[40:41]
    s_mov_b64 exec, vcc
    v_lshl_add_u32 v8, v8, 6, v15
    v_lshlrev_b32 v9, 4, v8
    v_lshlrev_b32 v8, 2, v8
    ds_write_b128 v9, v[32:35] offset:0
    ds_write_b32 v8, v16 offset:41088
    s_waitcnt lgkmcnt(0)
K2_slow_skip0:
    s_mov_b64 exec, s[42:43]
    s_cbranch_execz K2_slow_skip1
    buffer_load_dword v16, v10, s[12:15], s3 offen offset:8
    buffer_load_dwordx4 v[32:35], v14, s[12:15], 0 offen offset:32
    s_waitcnt vmcnt(0)
    v_bfe_u32 v8, v16, 4, 6
    v_lshlrev_b32 v9, 4, v8
    ds_add_rtn_u32 v15, v9, v17 offset:51360
    v_and_b32 v16, 0xfffc00, v16
    s_waitcnt lgkmcnt(0)
    v_cmp_gt_u32 vcc, 64, v15
    s_andn2_b64 s[42:43], s[42:43], vcc
    s_or_b64 s[60:61], s[60:61], s[42:43]
    s_mov_b64 exec, vcc
    v_lshl_add_u32 v8, v8, 6, v15
    v_lshlrev_b32 v9, 4, v8
    v_lshlrev_b32 v8, 2, v8
    ds_write_b128 v9, v[32:35] offset:0
    ds_write_b32 v8, v16 offset:41088
    s_waitcnt lgkmcnt(0)
K2_slow_skip1:
    s_mov_b64 exec, s[44:45]
    s_cbranch_execz K2_slow_skip2
    buffer_load_dword v16, v10, s[12:15], s3 offen offset:16
    buffer_load_dwordx4 v[32:35], v14, s[12:15], 0 offen offset:64
    s_waitcnt vmcnt(0)
    v_bfe_u32 v8, v16, 4, 6
    v_lshlrev_b32 v9, 4, v8
    ds_add_rtn_u32 v15, v9, v17 offset:51360
    v_and_b32 v16, 0xfffc00, v16
    s_waitcnt lgkmcnt(0)
    v_cmp_gt_u32 vcc, 64, v15
    s_andn2_b64 s[44:45], s[44:45], vcc
    s_or_b64 s[60:61], s[60:61], s[44:45]
    s_mov_b64 exec, vcc
    v_lshl_add_u32 v8, v8, 6, v15
    v_lshlrev_b32 v9, 4, v8
    v_lshlrev_b32 v8, 2, v8
    ds_write_b128 v9, v[32:35] offset:0
    ds_write_b32 v8, v16 offset:41088
    s_waitcnt lgkmcnt(0)
K2_slow_skip2:
    s_mov_b64 exec, s[46:47]
    s_cbranch_execz K2_slow_skip3
    buffer_load_dword v16, v10, s[12:15], s3 offen offset:24
    buffer_load_dwordx4 v[32:35], v14, s[12:15], 0 offen offset:96
    s_waitcnt vmcnt(0)
    v_bfe_u32 v8, v16, 4, 6
    v_lshlrev_b32 v9, 4, v8
    ds_add_rtn_u32 v15, v9, v17 offset:51360
    v_and_b32 v16, 0xfffc00, v16
    s_waitcnt lgkmcnt(0)
    v_cmp_gt_u32 vcc, 64, v15
    s_andn2_b64 s[46:47], s[46:47], vcc
    s_or_b64 s[60:61], s[60:61], s[46:47]
    s_mov_b64 exec, vcc
    v_lshl_add_u32 v8, v8, 6, v15
    v_lshlrev_b32 v9, 4, v8
    v_lshlrev_b32 v8, 2, v8
    ds_write_b128 v9, v[32:35] offset:0
    ds_write_b32 v8, v16 offset:41088
    s_waitcnt lgkmcnt(0)
K2_slow_skip3:
    s_mov_b64 exec, s[48:49]
    s_cbranch_execz K2_slow_skip4
    buffer_load_dword v16, v10, s[12:15], s3 offen offset:32
    buffer_load_dwordx4 v[32:35], v14, s[12:15], 0 offen offset:128
    s_waitcnt vmcnt(0)
    v_bfe_u32 v8, v16, 4, 6
    v_lshlrev_b32 v9, 4, v8
    ds_add_rtn_u32 v15, v9, v17 offset:51360
    v_and_b32 v16, 0xfffc00, v16
    s_waitcnt lgkmcnt(0)
    v_cmp_gt_u32 vcc, 64, v15
    s_andn2_b64 s[48:49], s[48:49], vcc
    s_or_b64 s[60:61], s[60:61], s[48:49]
    s_mov_b64 exec, vcc
    v_lshl_add_u32 v8, v8, 6, v15
    v_lshlrev_b32 v9, 4, v8
    v_lshlrev_b32 v8, 2, v8
    ds_write_b128 v9, v[32:35] offset:0
    ds_write_b32 v8, v16 offset:41088
    s_waitcnt lgkmcnt(0)
K2_slow_skip4:
    s_mov_b64 exec, s[50:51]
    s_cbranch_execz K2_slow_skip5
    buffer_load_dword v16, v10, s[12:15], s3 offen offset:40
    buffer_load_dwordx4 v[32:35], v14, s[12:15], 0 offen offset:160
    s_waitcnt vmcnt(0)
    v_bfe_u32 v8, v16, 4, 6
    v_lshlrev_b32 v9, 4, v8
    ds_add_rtn_u32 v15, v9, v17 offset:51360
    v_and_b32 v16, 0xfffc00, v16
    s_waitcnt lgkmcnt(0)
    v_cmp_gt_u32 vcc, 64, v15
    s_andn2_b64 s[50:51], s[50:51], vcc
    s_or_b64 s[60:61], s[60:61], s[50:51]
    s_mov_b64 exec, vcc
    v_lshl_add_u32 v8, v8, 6, v15
    v_lshlrev_b32 v9, 4, v8
    v_lshlrev_b32 v8, 2, v8
    ds_write_b128 v9, v[32:35] offset:0
    ds_write_b32 v8, v16 offset:41088
    s_waitcnt lgkmcnt(0)
K2_slow_skip5:
    s_mov_b64 exec, s[52:53]
    s_cbranch_execz K2_slow_skip6
    buffer_load_dword v16, v10, s[12:15], s3 offen offset:48
    buffer_load_dwordx4 v[32:35], v14, s[12:15], 0 offen offset:192
    s_waitcnt vmcnt(0)
    v_bfe_u32 v8, v16, 4, 6
    v_lshlrev_b32 v9, 4, v8
    ds_add_rtn_u32 v15, v9, v17 offset:51360
    v_and_b32 v16, 0xfffc00, v16
    s_waitcnt lgkmcnt(0)
    v_cmp_gt_u32 vcc, 64, v15
    s_andn2_b64 s[52:53], s[52:53], vcc
    s_or_b64 s[60:61], s[60:61], s[52:53]
    s_mov_b64 exec, vcc
    v_lshl_add_u32 v8, v8, 6, v15
    v_lshlrev_b32 v9, 4, v8
    v_lshlrev_b32 v8, 2, v8
    ds_write_b128 v9, v[32:35] offset:0
    ds_write_b32 v8, v16 offset:41088
    s_waitcnt lgkmcnt(0)
K2_slow_skip6:
    s_mov_b64 exec, s[54:55]
    s_cbranch_execz K2_slow_skip7
    buffer_load_dword v16, v10, s[12:15], s3 offen offset:56
    buffer_load_dwordx4 v[32:35], v14, s[12:15], 0 offen offset:224
    s_waitcnt vmcnt(0)
    v_bfe_u32 v8, v16, 4, 6
    v_lshlrev_b32 v9, 4, v8
    ds_add_rtn_u32 v15, v9, v17 offset:51360
    v_and_b32 v16, 0xfffc00, v16
    s_waitcnt lgkmcnt(0)
    v_cmp_gt_u32 vcc, 64, v15
    s_andn2_b64 s[54:55], s[54:55], vcc
    s_or_b64 s[60:61], s[60:61], s[54:55]
    s_mov_b64 exec, vcc
    v_lshl_add_u32 v8, v8, 6, v15
    v_lshlrev_b32 v9, 4, v8
    v_lshlrev_b32 v8, 2, v8
    ds_write_b128 v9, v[32:35] offset:0
    ds_write_b32 v8, v16 offset:41088
    s_waitcnt lgkmcnt(0)
K2_slow_skip7:
    s_mov_b64 exec, s[56:57]
    s_cbranch_execz K2_slow_skip8
    buffer_load_dword v16, v10, s[12:15], s3 offen offset:64
    buffer_load_dwordx4 v[32:35], v14, s[12:15], 0 offen offset:256
    s_waitcnt vmcnt(0)
    v_bfe_u32 v8, v16, 4, 6
    v_lshlrev_b32 v9, 4, v8
    ds_add_rtn_u32 v15, v9, v17 offset:51360
    v_and_b32 v16, 0xfffc00, v16
    s_waitcnt lgkmcnt(0)
    v_cmp_gt_u32 vcc, 64, v15
    s_andn2_b64 s[56:57], s[56:57], vcc
    s_or_b64 s[60:61], s[60:61], s[56:57]
    s_mov_b64 exec, vcc
    v_lshl_add_u32 v8, v8, 6, v15
    v_lshlrev_b32 v9, 4, v8
    v_lshlrev_b32 v8, 2, v8
    ds_write_b128 v9, v[32:35] offset:0
    ds_write_b32 v8, v16 offset:41088
    s_waitcnt lgkmcnt(0)
K2_slow_skip8:
    s_mov_b64 exec, s[58:59]
    s_cbranch_execz K2_slow_skip9
    buffer_load_dword v16, v10, s[12:15], s3 offen offset:72
    buffer_load_dwordx4 v[32:35], v14, s[12:15], 0 offen offset:288
    s_waitcnt vmcnt(0)
    v_bfe_u32 v8, v16, 4, 6
    v_lshlrev_b32 v9, 4, v8
    ds_add_rtn_u32 v15, v9, v17 offset:51360
    v_and_b32 v16, 0xfffc00, v16
    s_waitcnt lgkmcnt(0)
    v_cmp_gt_u32 vcc, 64, v15
    s_andn2_b64 s[58:59], s[58:59], vcc
    s_or_b64 s[60:61], s[60:61], s[58:59]
    s_mov_b64 exec, vcc
    v_lshl_add_u32 v8, v8, 6, v15
    v_lshlrev_b32 v9, 4, v8
    v_lshlrev_b32 v8, 2, v8
    ds_write_b128 v9, v[32:35] offset:0
    ds_write_b32 v8, v16 offset:41088
    s_waitcnt lgkmcnt(0)
K2_slow_skip9:
    s_mov_b64 exec, -1
    v_mov_b32 v9, 52000
    s_cmp_eq_u64 s[60:61], 0
    s_cbranch_scc1 K2_slow_nof
    ds_write_b32 v9, v17
K2_slow_nof:
    s_waitcnt lgkmcnt(0)
    s_barrier
    v_and_b32 v7, 7, v22
    s_mul_i32 s3, s20, 5
    v_add_u32 v11, s3, v7
    v_add_u32 v6, s3, v3
    s_add_u32 s3, s3, 4
    v_mov_b32 v1, s3
    v_lshlrev_b32 v12, 4, v11
    ds_read_b32 v12, v12 offset:51360
    v_lshlrev_b32 v13, 4, v6
    ds_read_b32 v13, v13 offset:51360
    v_lshlrev_b32 v14, 4, v1
    ds_read_b32 v14, v14 offset:51360
    ds_read_b32 v9, v9
    s_waitcnt lgkmcnt(0)
    v_min_u32 v12, 64, v12
    v_lshl_add_u32 v11, v12, 8, v11
    v_min_u32 v13, 64, v13
    v_lshl_add_u32 v6, v13, 8, v6
    v_min_u32 v14, 64, v14
    v_lshl_add_u32 v1, v14, 8, v1
    v_readfirstlane_b32 s36, v9
    v_mov_b32 v12, 0
    v_mov_b32 v13, 0
    s_add_u32 s36, s36, 1
    s_mov_b32 s35, 1
    s_branch K2_sched
K2_slow_next:
    s_cmp_eq_u32 s36, 2
    s_cbranch_scc1 K2_slow_batch
    s_add_u32 s37, s37, 20
    s_waitcnt vmcnt(0) lgkmcnt(0)
    s_branch K2_slow_win
K2_slow_fin:
    s_branch K2_epi
K2_code_end:
    s_endpgm
.section .rodata,"a"
.p2align 6
.amdhsa_kernel part_kernel
  .amdhsa_next_free_vgpr 64
  .amdhsa_next_free_sgpr 48
  .amdhsa_accum_offset 64
  .amdhsa_group_segment_fixed_size 0
  .amdhsa_kernarg_size 88
  .amdhsa_user_sgpr_count 2
  .amdhsa_user_sgpr_kernarg_segment_ptr 1
  .amdhsa_system_sgpr_workgroup_id_x 1
.end_amdhsa_kernel
.p2align 6
.amdhsa_kernel main_kernel
  .amdhsa_next_free_vgpr 256
  .amdhsa_next_free_sgpr 102
  .amdhsa_accum_offset 256
  .amdhsa_group_segment_fixed_size 0
  .amdhsa_kernarg_size 88
  .amdhsa_user_sgpr_count 2
  .amdhsa_user_sgpr_kernarg_segment_ptr 1
  .amdhsa_system_sgpr_workgroup_id_x 1
.end_amdhsa_kernel
```
